```python
import torch

def _softmax(x, axis=-1):
    return torch.softmax(x, dim=axis)
def _gelu(x):
    return torch.nn.functional.gelu(x, approximate="tanh")
def _silu(x):
    return torch.nn.functional.silu(x)
def _sigmoid(x):
    return torch.sigmoid(x)
def _layernorm(x, axis=-1, eps=1e-5):
    m = x.mean(dim=axis, keepdim=True)
    v = x.var(dim=axis, keepdim=True, unbiased=False)
    return (x - m) / torch.sqrt(v + eps)
def _scatter_add(tgt, idx, src, axis=0):
    return tgt.clone().index_add_(axis, idx, src)
def _segment_sum(src, seg, n):
    out = torch.zeros((n,) + src.shape[1:], dtype=src.dtype)
    return out.index_add_(0, seg, src)
def _pad(x, pw):
    flat = tuple(v for pair in reversed(pw) for v in pair)
    return torch.nn.functional.pad(x, flat)

kernel_name = 'sequential_preLN__softmax_full_mha__geglu_ffn__prompt'

def setup_inputs():

    _w = (lambda a: (lambda t: t.to(torch.bfloat16) if t.is_floating_point() else t)(torch.as_tensor(a)))
    def _A_setup():
        B, S, D = 1, 2048, 448
        return {
            "x": _w((lambda *s: torch.randn(*s, dtype=torch.bfloat16) * 0.05)(B, S, D)),
            "wqkv": _w((lambda *s: torch.randn(*s, dtype=torch.bfloat16) * 0.05)(D, 3 * D)),
            "wo": _w((lambda *s: torch.randn(*s, dtype=torch.bfloat16) * 0.05)(D, D)),
        }
    _A_in = _A_setup()

    def _B_setup():
        B, S, D, F = 1, 2048, 448, 1792
        return {
            "x": _w((lambda *s: torch.randn(*s, dtype=torch.bfloat16) * 0.05)(B, S, D)),
            "w_gate": _w((lambda *s: torch.randn(*s, dtype=torch.bfloat16) * 0.05)(D, F)),
            "w_up": _w((lambda *s: torch.randn(*s, dtype=torch.bfloat16) * 0.05)(D, F)),
            "w_down": _w((lambda *s: torch.randn(*s, dtype=torch.bfloat16) * 0.05)(F, D)),
        }
    _B_in = _B_setup()

    return {
        "A_x": _A_in["x"],
        "A_wqkv": _A_in["wqkv"],
        "A_wo": _A_in["wo"],
        "B_x": _B_in["x"],
        "B_w_gate": _B_in["w_gate"],
        "B_w_up": _B_in["w_up"],
        "B_w_down": _B_in["w_down"],
    }

def reference(A_x, A_wqkv, A_wo, B_x, B_w_gate, B_w_up, B_w_down):
    def _A_ref(x, wqkv, wo):
        B, S, D = x.shape
        H = 16; Dh = D // H
        qkv = (lambda x, *d: x.permute(*d))((x @ wqkv).reshape(B, S, 3, H, Dh), 2, 0, 3, 1, 4)
        q, k, v = qkv[0], qkv[1], qkv[2]
        scale = Dh ** -0.5
        scores = torch.einsum("bhqd,bhkd->bhqk", q, k) * scale
        p = _softmax(scores, axis=-1)
        o = torch.einsum("bhqk,bhkd->bhqd", p, v)
        return (lambda x, *d: x.permute(*d))(o, 0, 2, 1, 3).reshape(B, S, D) @ wo

    def _B_ref(x, w_gate, w_up, w_down):
        return (_gelu(x @ w_gate) * (x @ w_up)) @ w_down

    x = A_x
    h = x + _A_ref(_layernorm(x, axis=-1), A_wqkv, A_wo)
    h2 = h + _B_ref(_layernorm(h, axis=-1), B_w_gate, B_w_up, B_w_down)
    return h2
```

```asm
; @launch kernel=k1_qkv_kernel grid=(256,1,1) block=(256,1,1) lds=155648
; @launch kernel=k2_attn_kernel grid=(256,1,1) block=(512,1,1) lds=147456
; @launch kernel=k3_wo_kernel grid=(252,1,1) block=(256,1,1) lds=91136
; @launch kernel=k4_ffn1_kernel grid=(224,1,1) block=(512,1,1) lds=163840
; @launch kernel=k5_down_kernel grid=(224,1,1) block=(512,1,1) lds=131072
.amdgcn_target "amdgcn-amd-amdhsa--gfx950"
.text
.globl k1_qkv_kernel
.p2align 8
.type k1_qkv_kernel,@function
k1_qkv_kernel:
    s_cmp_ge_u32 s2, 256
    s_cbranch_scc1 K1_END
    s_cmp_ge_u32 s2, 8
    s_cbranch_scc1 K1_NOPF
    s_getpc_b64 s[92:93]
K1_PC:
    s_add_u32 s92, s92, k2_attn_kernel-K1_PC
    s_addc_u32 s93, s93, 0
    s_mov_b32 s94, k3_wo_kernel-k2_attn_kernel
    s_mov_b32 s95, 0x00020000
    v_lshlrev_b32 v3, 7, v0
    buffer_load_dword v3, v3, s[92:95], 0 offen
K1_NOPF:
    s_load_dwordx2 s[4:5], s[0:1], 0
    s_load_dwordx2 s[6:7], s[0:1], 8
    s_load_dwordx2 s[8:9], s[0:1], 72
    s_and_b32 s24, s2, 7
    s_lshr_b32 s25, s2, 3
    s_lshr_b32 s20, s24, 1
    s_lshl_b32 s20, s20, 3
    s_lshr_b32 s26, s25, 2
    s_add_u32 s20, s20, s26
    s_and_b32 s21, s24, 1
    s_lshl_b32 s21, s21, 2
    s_and_b32 s26, s25, 3
    s_add_u32 s21, s21, s26
    v_lshrrev_b32 v1, 6, v0
    v_and_b32 v2, 63, v0
    s_nop 0
    v_readfirstlane_b32 s22, v1
    s_waitcnt lgkmcnt(0)
    s_mov_b32 s12, s4
    s_mov_b32 s13, s5
    s_mov_b32 s14, 0x1c0000
    s_mov_b32 s15, 0x00020000
    s_mov_b32 s16, s6
    s_mov_b32 s17, s7
    s_mov_b32 s18, 0x126000
    s_mov_b32 s19, 0x00020000
    s_mov_b32 s64, s8
    s_mov_b32 s65, s9
    s_mov_b32 s66, 0x600000
    s_mov_b32 s67, 0x00020000
    s_mul_i32 s23, s20, 0xe000
    v_lshrrev_b32 v172, 2, v0
    v_and_b32 v173, 3, v0
    v_mul_u32_u24 v174, 0x380, v172
    v_lshl_add_u32 v175, v173, 4, v174
    buffer_load_dwordx4 v[116:119], v175, s[12:15], s23 offen offset:0
    buffer_load_dwordx4 v[120:123], v175, s[12:15], s23 offen offset:64
    buffer_load_dwordx4 v[124:127], v175, s[12:15], s23 offen offset:128
    buffer_load_dwordx4 v[128:131], v175, s[12:15], s23 offen offset:192
    buffer_load_dwordx4 v[132:135], v175, s[12:15], s23 offen offset:256
    buffer_load_dwordx4 v[136:139], v175, s[12:15], s23 offen offset:320
    buffer_load_dwordx4 v[140:143], v175, s[12:15], s23 offen offset:384
    buffer_load_dwordx4 v[144:147], v175, s[12:15], s23 offen offset:448
    buffer_load_dwordx4 v[148:151], v175, s[12:15], s23 offen offset:512
    buffer_load_dwordx4 v[152:155], v175, s[12:15], s23 offen offset:576
    buffer_load_dwordx4 v[156:159], v175, s[12:15], s23 offen offset:640
    buffer_load_dwordx4 v[160:163], v175, s[12:15], s23 offen offset:704
    buffer_load_dwordx4 v[164:167], v175, s[12:15], s23 offen offset:768
    buffer_load_dwordx4 v[168:171], v175, s[12:15], s23 offen offset:832
    v_lshrrev_b32 v184, 3, v2
    v_lshl_add_u32 v184, v1, 3, v184
    v_mul_u32_u24 v184, 0xa80, v184
    v_lshrrev_b32 v185, 4, v2
    v_and_b32 v185, 1, v185
    v_lshlrev_b32 v185, 2, v185
    v_and_b32 v186, 7, v2
    v_xor_b32 v185, v185, v186
    v_lshl_add_u32 v184, v185, 4, v184
    s_mul_i32 s26, s21, 112
    v_add_u32 v184, s26, v184
    s_lshl_b32 s27, s22, 10
    s_lshr_b32 s26, s25, 2
    s_mul_i32 s26, s26, 56
    s_mul_i32 s28, s22, 14
    s_add_u32 s26, s26, s28
    s_mul_i32 s26, s26, 0xa80
    s_mul_i32 s28, s21, 112
    s_add_u32 s26, s26, s28
    v_lshrrev_b32 v185, 3, v2
    v_mul_u32_u24 v187, 0xa80, v185
    v_and_b32 v186, 7, v2
    v_lshl_add_u32 v187, v186, 4, v187
    v_min_u32 v185, 5, v185
    v_add_u32 v185, 8, v185
    v_mul_u32_u24 v185, 0xa80, v185
    v_lshl_add_u32 v185, v186, 4, v185
    buffer_load_dwordx4 v[188:191], v187, s[16:19], s26 offen offset:0
    buffer_load_dwordx4 v[188:191], v185, s[16:19], s26 offen offset:0
    buffer_load_dwordx4 v[188:191], v187, s[16:19], s26 offen offset:896
    buffer_load_dwordx4 v[188:191], v185, s[16:19], s26 offen offset:896
    buffer_load_dwordx4 v[188:191], v187, s[16:19], s26 offen offset:1792
    buffer_load_dwordx4 v[188:191], v185, s[16:19], s26 offen offset:1792
    v_mov_b32 v176, 0
    v_mov_b32 v177, 0
    v_mov_b32 v178, 0
    v_mov_b32 v179, 0
    s_waitcnt vmcnt(19)
    v_lshlrev_b32 v4, 16, v116
    v_and_b32 v5, 0xffff0000, v116
    v_lshlrev_b32 v6, 16, v117
    v_and_b32 v7, 0xffff0000, v117
    v_lshlrev_b32 v8, 16, v118
    v_and_b32 v9, 0xffff0000, v118
    v_lshlrev_b32 v10, 16, v119
    v_and_b32 v11, 0xffff0000, v119
    v_pk_add_f32 v[176:177], v[176:177], v[4:5]
    v_pk_add_f32 v[178:179], v[178:179], v[6:7]
    v_pk_add_f32 v[176:177], v[176:177], v[8:9]
    v_pk_add_f32 v[178:179], v[178:179], v[10:11]
    s_waitcnt vmcnt(18)
    v_lshlrev_b32 v12, 16, v120
    v_and_b32 v13, 0xffff0000, v120
    v_lshlrev_b32 v14, 16, v121
    v_and_b32 v15, 0xffff0000, v121
    v_lshlrev_b32 v16, 16, v122
    v_and_b32 v17, 0xffff0000, v122
    v_lshlrev_b32 v18, 16, v123
    v_and_b32 v19, 0xffff0000, v123
    v_pk_add_f32 v[176:177], v[176:177], v[12:13]
    v_pk_add_f32 v[178:179], v[178:179], v[14:15]
    v_pk_add_f32 v[176:177], v[176:177], v[16:17]
    v_pk_add_f32 v[178:179], v[178:179], v[18:19]
    s_waitcnt vmcnt(17)
    v_lshlrev_b32 v20, 16, v124
    v_and_b32 v21, 0xffff0000, v124
    v_lshlrev_b32 v22, 16, v125
    v_and_b32 v23, 0xffff0000, v125
    v_lshlrev_b32 v24, 16, v126
    v_and_b32 v25, 0xffff0000, v126
    v_lshlrev_b32 v26, 16, v127
    v_and_b32 v27, 0xffff0000, v127
    v_pk_add_f32 v[176:177], v[176:177], v[20:21]
    v_pk_add_f32 v[178:179], v[178:179], v[22:23]
    v_pk_add_f32 v[176:177], v[176:177], v[24:25]
    v_pk_add_f32 v[178:179], v[178:179], v[26:27]
    s_waitcnt vmcnt(16)
    v_lshlrev_b32 v28, 16, v128
    v_and_b32 v29, 0xffff0000, v128
    v_lshlrev_b32 v30, 16, v129
    v_and_b32 v31, 0xffff0000, v129
    v_lshlrev_b32 v32, 16, v130
    v_and_b32 v33, 0xffff0000, v130
    v_lshlrev_b32 v34, 16, v131
    v_and_b32 v35, 0xffff0000, v131
    v_pk_add_f32 v[176:177], v[176:177], v[28:29]
    v_pk_add_f32 v[178:179], v[178:179], v[30:31]
    v_pk_add_f32 v[176:177], v[176:177], v[32:33]
    v_pk_add_f32 v[178:179], v[178:179], v[34:35]
    s_waitcnt vmcnt(15)
    v_lshlrev_b32 v36, 16, v132
    v_and_b32 v37, 0xffff0000, v132
    v_lshlrev_b32 v38, 16, v133
    v_and_b32 v39, 0xffff0000, v133
    v_lshlrev_b32 v40, 16, v134
    v_and_b32 v41, 0xffff0000, v134
    v_lshlrev_b32 v42, 16, v135
    v_and_b32 v43, 0xffff0000, v135
    v_pk_add_f32 v[176:177], v[176:177], v[36:37]
    v_pk_add_f32 v[178:179], v[178:179], v[38:39]
    v_pk_add_f32 v[176:177], v[176:177], v[40:41]
    v_pk_add_f32 v[178:179], v[178:179], v[42:43]
    s_waitcnt vmcnt(14)
    v_lshlrev_b32 v44, 16, v136
    v_and_b32 v45, 0xffff0000, v136
    v_lshlrev_b32 v46, 16, v137
    v_and_b32 v47, 0xffff0000, v137
    v_lshlrev_b32 v48, 16, v138
    v_and_b32 v49, 0xffff0000, v138
    v_lshlrev_b32 v50, 16, v139
    v_and_b32 v51, 0xffff0000, v139
    v_pk_add_f32 v[176:177], v[176:177], v[44:45]
    v_pk_add_f32 v[178:179], v[178:179], v[46:47]
    v_pk_add_f32 v[176:177], v[176:177], v[48:49]
    v_pk_add_f32 v[178:179], v[178:179], v[50:51]
    s_waitcnt vmcnt(13)
    v_lshlrev_b32 v52, 16, v140
    v_and_b32 v53, 0xffff0000, v140
    v_lshlrev_b32 v54, 16, v141
    v_and_b32 v55, 0xffff0000, v141
    v_lshlrev_b32 v56, 16, v142
    v_and_b32 v57, 0xffff0000, v142
    v_lshlrev_b32 v58, 16, v143
    v_and_b32 v59, 0xffff0000, v143
    v_pk_add_f32 v[176:177], v[176:177], v[52:53]
    v_pk_add_f32 v[178:179], v[178:179], v[54:55]
    v_pk_add_f32 v[176:177], v[176:177], v[56:57]
    v_pk_add_f32 v[178:179], v[178:179], v[58:59]
    s_waitcnt vmcnt(12)
    v_lshlrev_b32 v60, 16, v144
    v_and_b32 v61, 0xffff0000, v144
    v_lshlrev_b32 v62, 16, v145
    v_and_b32 v63, 0xffff0000, v145
    v_lshlrev_b32 v64, 16, v146
    v_and_b32 v65, 0xffff0000, v146
    v_lshlrev_b32 v66, 16, v147
    v_and_b32 v67, 0xffff0000, v147
    v_pk_add_f32 v[176:177], v[176:177], v[60:61]
    v_pk_add_f32 v[178:179], v[178:179], v[62:63]
    v_pk_add_f32 v[176:177], v[176:177], v[64:65]
    v_pk_add_f32 v[178:179], v[178:179], v[66:67]
    s_waitcnt vmcnt(11)
    v_lshlrev_b32 v68, 16, v148
    v_and_b32 v69, 0xffff0000, v148
    v_lshlrev_b32 v70, 16, v149
    v_and_b32 v71, 0xffff0000, v149
    v_lshlrev_b32 v72, 16, v150
    v_and_b32 v73, 0xffff0000, v150
    v_lshlrev_b32 v74, 16, v151
    v_and_b32 v75, 0xffff0000, v151
    v_pk_add_f32 v[176:177], v[176:177], v[68:69]
    v_pk_add_f32 v[178:179], v[178:179], v[70:71]
    v_pk_add_f32 v[176:177], v[176:177], v[72:73]
    v_pk_add_f32 v[178:179], v[178:179], v[74:75]
    s_waitcnt vmcnt(10)
    v_lshlrev_b32 v76, 16, v152
    v_and_b32 v77, 0xffff0000, v152
    v_lshlrev_b32 v78, 16, v153
    v_and_b32 v79, 0xffff0000, v153
    v_lshlrev_b32 v80, 16, v154
    v_and_b32 v81, 0xffff0000, v154
    v_lshlrev_b32 v82, 16, v155
    v_and_b32 v83, 0xffff0000, v155
    v_pk_add_f32 v[176:177], v[176:177], v[76:77]
    v_pk_add_f32 v[178:179], v[178:179], v[78:79]
    v_pk_add_f32 v[176:177], v[176:177], v[80:81]
    v_pk_add_f32 v[178:179], v[178:179], v[82:83]
    s_waitcnt vmcnt(9)
    v_lshlrev_b32 v84, 16, v156
    v_and_b32 v85, 0xffff0000, v156
    v_lshlrev_b32 v86, 16, v157
    v_and_b32 v87, 0xffff0000, v157
    v_lshlrev_b32 v88, 16, v158
    v_and_b32 v89, 0xffff0000, v158
    v_lshlrev_b32 v90, 16, v159
    v_and_b32 v91, 0xffff0000, v159
    v_pk_add_f32 v[176:177], v[176:177], v[84:85]
    v_pk_add_f32 v[178:179], v[178:179], v[86:87]
    v_pk_add_f32 v[176:177], v[176:177], v[88:89]
    v_pk_add_f32 v[178:179], v[178:179], v[90:91]
    s_waitcnt vmcnt(8)
    v_lshlrev_b32 v92, 16, v160
    v_and_b32 v93, 0xffff0000, v160
    v_lshlrev_b32 v94, 16, v161
    v_and_b32 v95, 0xffff0000, v161
    v_lshlrev_b32 v96, 16, v162
    v_and_b32 v97, 0xffff0000, v162
    v_lshlrev_b32 v98, 16, v163
    v_and_b32 v99, 0xffff0000, v163
    v_pk_add_f32 v[176:177], v[176:177], v[92:93]
    v_pk_add_f32 v[178:179], v[178:179], v[94:95]
    v_pk_add_f32 v[176:177], v[176:177], v[96:97]
    v_pk_add_f32 v[178:179], v[178:179], v[98:99]
    s_waitcnt vmcnt(7)
    v_lshlrev_b32 v100, 16, v164
    v_and_b32 v101, 0xffff0000, v164
    v_lshlrev_b32 v102, 16, v165
    v_and_b32 v103, 0xffff0000, v165
    v_lshlrev_b32 v104, 16, v166
    v_and_b32 v105, 0xffff0000, v166
    v_lshlrev_b32 v106, 16, v167
    v_and_b32 v107, 0xffff0000, v167
    v_pk_add_f32 v[176:177], v[176:177], v[100:101]
    v_pk_add_f32 v[178:179], v[178:179], v[102:103]
    v_pk_add_f32 v[176:177], v[176:177], v[104:105]
    v_pk_add_f32 v[178:179], v[178:179], v[106:107]
    s_waitcnt vmcnt(6)
    v_lshlrev_b32 v108, 16, v168
    v_and_b32 v109, 0xffff0000, v168
    v_lshlrev_b32 v110, 16, v169
    v_and_b32 v111, 0xffff0000, v169
    v_lshlrev_b32 v112, 16, v170
    v_and_b32 v113, 0xffff0000, v170
    v_lshlrev_b32 v114, 16, v171
    v_and_b32 v115, 0xffff0000, v171
    v_pk_add_f32 v[176:177], v[176:177], v[108:109]
    v_pk_add_f32 v[178:179], v[178:179], v[110:111]
    v_pk_add_f32 v[176:177], v[176:177], v[112:113]
    v_pk_add_f32 v[178:179], v[178:179], v[114:115]
    s_add_u32 m0, s27, 0
    s_mov_b32 s28, 0x0
    buffer_load_dwordx4 v184, s[16:19], s28 offen lds
    v_pk_add_f32 v[176:177], v[176:177], v[178:179]
    v_add_f32 v180, v176, v177
    s_nop 1
    v_add_f32_dpp v180, v180, v180 quad_perm:[1,0,3,2] row_mask:0xf bank_mask:0xf
    s_nop 1
    v_add_f32_dpp v180, v180, v180 quad_perm:[2,3,0,1] row_mask:0xf bank_mask:0xf
    v_mul_f32 v182, 0xbb124925, v180
    v_mov_b32 v183, v182
    v_mov_b32 v176, 0
    v_mov_b32 v177, 0
    v_mov_b32 v178, 0
    v_mov_b32 v179, 0
    s_add_u32 m0, s27, 4096
    s_mov_b32 s28, 0x380
    buffer_load_dwordx4 v184, s[16:19], s28 offen lds
    v_pk_add_f32 v[4:5], v[4:5], v[182:183]
    v_pk_add_f32 v[6:7], v[6:7], v[182:183]
    v_pk_add_f32 v[8:9], v[8:9], v[182:183]
    v_pk_add_f32 v[10:11], v[10:11], v[182:183]
    v_pk_add_f32 v[12:13], v[12:13], v[182:183]
    v_pk_add_f32 v[14:15], v[14:15], v[182:183]
    v_pk_add_f32 v[16:17], v[16:17], v[182:183]
    v_pk_add_f32 v[18:19], v[18:19], v[182:183]
    v_pk_add_f32 v[20:21], v[20:21], v[182:183]
    v_pk_add_f32 v[22:23], v[22:23], v[182:183]
    v_pk_add_f32 v[24:25], v[24:25], v[182:183]
    s_add_u32 m0, s27, 8192
    s_mov_b32 s28, 0x700
    buffer_load_dwordx4 v184, s[16:19], s28 offen lds
    v_pk_add_f32 v[26:27], v[26:27], v[182:183]
    v_pk_add_f32 v[28:29], v[28:29], v[182:183]
    v_pk_add_f32 v[30:31], v[30:31], v[182:183]
    v_pk_add_f32 v[32:33], v[32:33], v[182:183]
    v_pk_add_f32 v[34:35], v[34:35], v[182:183]
    v_pk_add_f32 v[36:37], v[36:37], v[182:183]
    v_pk_add_f32 v[38:39], v[38:39], v[182:183]
    v_pk_add_f32 v[40:41], v[40:41], v[182:183]
    v_pk_add_f32 v[42:43], v[42:43], v[182:183]
    v_pk_add_f32 v[44:45], v[44:45], v[182:183]
    v_pk_add_f32 v[46:47], v[46:47], v[182:183]
    s_add_u32 m0, s27, 12288
    s_mov_b32 s28, 0x15000
    buffer_load_dwordx4 v184, s[16:19], s28 offen lds
    v_pk_add_f32 v[48:49], v[48:49], v[182:183]
    v_pk_add_f32 v[50:51], v[50:51], v[182:183]
    v_pk_add_f32 v[52:53], v[52:53], v[182:183]
    v_pk_add_f32 v[54:55], v[54:55], v[182:183]
    v_pk_add_f32 v[56:57], v[56:57], v[182:183]
    v_pk_add_f32 v[58:59], v[58:59], v[182:183]
    v_pk_add_f32 v[60:61], v[60:61], v[182:183]
    v_pk_add_f32 v[62:63], v[62:63], v[182:183]
    v_pk_add_f32 v[64:65], v[64:65], v[182:183]
    v_pk_add_f32 v[66:67], v[66:67], v[182:183]
    v_pk_add_f32 v[68:69], v[68:69], v[182:183]
    s_add_u32 m0, s27, 16384
    s_mov_b32 s28, 0x15380
    buffer_load_dwordx4 v184, s[16:19], s28 offen lds
    v_pk_add_f32 v[70:71], v[70:71], v[182:183]
    v_pk_add_f32 v[72:73], v[72:73], v[182:183]
    v_pk_add_f32 v[74:75], v[74:75], v[182:183]
    v_pk_add_f32 v[76:77], v[76:77], v[182:183]
    v_pk_add_f32 v[78:79], v[78:79], v[182:183]
    v_pk_add_f32 v[80:81], v[80:81], v[182:183]
    v_pk_add_f32 v[82:83], v[82:83], v[182:183]
    v_pk_add_f32 v[84:85], v[84:85], v[182:183]
    v_pk_add_f32 v[86:87], v[86:87], v[182:183]
    v_pk_add_f32 v[88:89], v[88:89], v[182:183]
    v_pk_add_f32 v[90:91], v[90:91], v[182:183]
    s_add_u32 m0, s27, 20480
    s_mov_b32 s28, 0x15700
    buffer_load_dwordx4 v184, s[16:19], s28 offen lds
    v_pk_add_f32 v[92:93], v[92:93], v[182:183]
    v_pk_add_f32 v[94:95], v[94:95], v[182:183]
    v_pk_add_f32 v[96:97], v[96:97], v[182:183]
    v_pk_add_f32 v[98:99], v[98:99], v[182:183]
    v_pk_add_f32 v[100:101], v[100:101], v[182:183]
    v_pk_add_f32 v[102:103], v[102:103], v[182:183]
    v_pk_add_f32 v[104:105], v[104:105], v[182:183]
    v_pk_add_f32 v[106:107], v[106:107], v[182:183]
    v_pk_add_f32 v[108:109], v[108:109], v[182:183]
    v_pk_add_f32 v[110:111], v[110:111], v[182:183]
    v_pk_add_f32 v[112:113], v[112:113], v[182:183]
    s_add_u32 m0, s27, 24576
    s_mov_b32 s28, 0x2a000
    buffer_load_dwordx4 v184, s[16:19], s28 offen lds
    v_pk_add_f32 v[114:115], v[114:115], v[182:183]
    v_pk_fma_f32 v[176:177], v[4:5], v[4:5], v[176:177]
    v_pk_fma_f32 v[178:179], v[6:7], v[6:7], v[178:179]
    v_pk_fma_f32 v[176:177], v[8:9], v[8:9], v[176:177]
    v_pk_fma_f32 v[178:179], v[10:11], v[10:11], v[178:179]
    v_pk_fma_f32 v[176:177], v[12:13], v[12:13], v[176:177]
    v_pk_fma_f32 v[178:179], v[14:15], v[14:15], v[178:179]
    v_pk_fma_f32 v[176:177], v[16:17], v[16:17], v[176:177]
    v_pk_fma_f32 v[178:179], v[18:19], v[18:19], v[178:179]
    v_pk_fma_f32 v[176:177], v[20:21], v[20:21], v[176:177]
    v_pk_fma_f32 v[178:179], v[22:23], v[22:23], v[178:179]
    s_add_u32 m0, s27, 28672
    s_mov_b32 s28, 0x2a380
    buffer_load_dwordx4 v184, s[16:19], s28 offen lds
    v_pk_fma_f32 v[176:177], v[24:25], v[24:25], v[176:177]
    v_pk_fma_f32 v[178:179], v[26:27], v[26:27], v[178:179]
    v_pk_fma_f32 v[176:177], v[28:29], v[28:29], v[176:177]
    v_pk_fma_f32 v[178:179], v[30:31], v[30:31], v[178:179]
    v_pk_fma_f32 v[176:177], v[32:33], v[32:33], v[176:177]
    v_pk_fma_f32 v[178:179], v[34:35], v[34:35], v[178:179]
    v_pk_fma_f32 v[176:177], v[36:37], v[36:37], v[176:177]
    v_pk_fma_f32 v[178:179], v[38:39], v[38:39], v[178:179]
    v_pk_fma_f32 v[176:177], v[40:41], v[40:41], v[176:177]
    v_pk_fma_f32 v[178:179], v[42:43], v[42:43], v[178:179]
    v_pk_fma_f32 v[176:177], v[44:45], v[44:45], v[176:177]
    s_add_u32 m0, s27, 32768
    s_mov_b32 s28, 0x2a700
    buffer_load_dwordx4 v184, s[16:19], s28 offen lds
    v_pk_fma_f32 v[178:179], v[46:47], v[46:47], v[178:179]
    v_pk_fma_f32 v[176:177], v[48:49], v[48:49], v[176:177]
    v_pk_fma_f32 v[178:179], v[50:51], v[50:51], v[178:179]
    v_pk_fma_f32 v[176:177], v[52:53], v[52:53], v[176:177]
    v_pk_fma_f32 v[178:179], v[54:55], v[54:55], v[178:179]
    v_pk_fma_f32 v[176:177], v[56:57], v[56:57], v[176:177]
    v_pk_fma_f32 v[178:179], v[58:59], v[58:59], v[178:179]
    v_pk_fma_f32 v[176:177], v[60:61], v[60:61], v[176:177]
    v_pk_fma_f32 v[178:179], v[62:63], v[62:63], v[178:179]
    v_pk_fma_f32 v[176:177], v[64:65], v[64:65], v[176:177]
    v_pk_fma_f32 v[178:179], v[66:67], v[66:67], v[178:179]
    v_pk_fma_f32 v[176:177], v[68:69], v[68:69], v[176:177]
    s_add_u32 m0, s27, 36864
    s_mov_b32 s28, 0x3f000
    buffer_load_dwordx4 v184, s[16:19], s28 offen lds
    v_pk_fma_f32 v[178:179], v[70:71], v[70:71], v[178:179]
    v_pk_fma_f32 v[176:177], v[72:73], v[72:73], v[176:177]
    v_pk_fma_f32 v[178:179], v[74:75], v[74:75], v[178:179]
    v_pk_fma_f32 v[176:177], v[76:77], v[76:77], v[176:177]
    v_pk_fma_f32 v[178:179], v[78:79], v[78:79], v[178:179]
    v_pk_fma_f32 v[176:177], v[80:81], v[80:81], v[176:177]
    v_pk_fma_f32 v[178:179], v[82:83], v[82:83], v[178:179]
    v_pk_fma_f32 v[176:177], v[84:85], v[84:85], v[176:177]
    v_pk_fma_f32 v[178:179], v[86:87], v[86:87], v[178:179]
    v_pk_fma_f32 v[176:177], v[88:89], v[88:89], v[176:177]
    v_pk_fma_f32 v[178:179], v[90:91], v[90:91], v[178:179]
    s_add_u32 m0, s27, 40960
    s_mov_b32 s28, 0x3f380
    buffer_load_dwordx4 v184, s[16:19], s28 offen lds
    v_pk_fma_f32 v[176:177], v[92:93], v[92:93], v[176:177]
    v_pk_fma_f32 v[178:179], v[94:95], v[94:95], v[178:179]
    v_pk_fma_f32 v[176:177], v[96:97], v[96:97], v[176:177]
    v_pk_fma_f32 v[178:179], v[98:99], v[98:99], v[178:179]
    v_pk_fma_f32 v[176:177], v[100:101], v[100:101], v[176:177]
    v_pk_fma_f32 v[178:179], v[102:103], v[102:103], v[178:179]
    v_pk_fma_f32 v[176:177], v[104:105], v[104:105], v[176:177]
    v_pk_fma_f32 v[178:179], v[106:107], v[106:107], v[178:179]
    v_pk_fma_f32 v[176:177], v[108:109], v[108:109], v[176:177]
    v_pk_fma_f32 v[178:179], v[110:111], v[110:111], v[178:179]
    v_pk_fma_f32 v[176:177], v[112:113], v[112:113], v[176:177]
    s_add_u32 m0, s27, 45056
    s_mov_b32 s28, 0x3f700
    buffer_load_dwordx4 v184, s[16:19], s28 offen lds
    v_pk_fma_f32 v[178:179], v[114:115], v[114:115], v[178:179]
    v_pk_add_f32 v[176:177], v[176:177], v[178:179]
    v_add_f32 v180, v176, v177
    s_nop 1
    v_add_f32_dpp v180, v180, v180 quad_perm:[1,0,3,2] row_mask:0xf bank_mask:0xf
    s_nop 1
    v_add_f32_dpp v180, v180, v180 quad_perm:[2,3,0,1] row_mask:0xf bank_mask:0xf
    v_mov_b32 v183, 0x3727c5ac
    v_fmac_f32 v183, 0x3b124925, v180
    v_rsq_f32 v182, v183
    s_nop 0
    s_add_u32 m0, s27, 49152
    s_mov_b32 s28, 0x54000
    buffer_load_dwordx4 v184, s[16:19], s28 offen lds
    v_mov_b32 v183, v182
    v_lshrrev_b32 v180, 1, v172
    v_and_b32 v180, 7, v180
    v_xor_b32 v180, v180, v173
    v_lshl_add_u32 v180, v180, 4, v174
    v_add_u32 v180, 0x18000, v180
    v_xor_b32 v181, 64, v180
    v_pk_mul_f32 v[4:5], v[4:5], v[182:183]
    v_pk_mul_f32 v[6:7], v[6:7], v[182:183]
    v_pk_mul_f32 v[8:9], v[8:9], v[182:183]
    v_pk_mul_f32 v[10:11], v[10:11], v[182:183]
    s_add_u32 m0, s27, 53248
    s_mov_b32 s28, 0x54380
    buffer_load_dwordx4 v184, s[16:19], s28 offen lds
    v_cvt_pk_bf16_f32 v116, v4, v5
    v_cvt_pk_bf16_f32 v117, v6, v7
    v_cvt_pk_bf16_f32 v118, v8, v9
    v_cvt_pk_bf16_f32 v119, v10, v11
    ds_write_b128 v180, v[116:119] offset:0
    v_pk_mul_f32 v[12:13], v[12:13], v[182:183]
    v_pk_mul_f32 v[14:15], v[14:15], v[182:183]
    v_pk_mul_f32 v[16:17], v[16:17], v[182:183]
    v_pk_mul_f32 v[18:19], v[18:19], v[182:183]
    v_cvt_pk_bf16_f32 v120, v12, v13
    v_cvt_pk_bf16_f32 v121, v14, v15
    s_add_u32 m0, s27, 57344
    s_mov_b32 s28, 0x54700
    buffer_load_dwordx4 v184, s[16:19], s28 offen lds
    v_cvt_pk_bf16_f32 v122, v16, v17
    v_cvt_pk_bf16_f32 v123, v18, v19
    ds_write_b128 v181, v[120:123] offset:0
    v_pk_mul_f32 v[20:21], v[20:21], v[182:183]
    v_pk_mul_f32 v[22:23], v[22:23], v[182:183]
    v_pk_mul_f32 v[24:25], v[24:25], v[182:183]
    v_pk_mul_f32 v[26:27], v[26:27], v[182:183]
    v_cvt_pk_bf16_f32 v124, v20, v21
    v_cvt_pk_bf16_f32 v125, v22, v23
    v_cvt_pk_bf16_f32 v126, v24, v25
    v_cvt_pk_bf16_f32 v127, v26, v27
    s_add_u32 m0, s27, 61440
    s_mov_b32 s28, 0x69000
    buffer_load_dwordx4 v184, s[16:19], s28 offen lds
    ds_write_b128 v180, v[124:127] offset:128
    v_pk_mul_f32 v[28:29], v[28:29], v[182:183]
    v_pk_mul_f32 v[30:31], v[30:31], v[182:183]
    v_pk_mul_f32 v[32:33], v[32:33], v[182:183]
    v_pk_mul_f32 v[34:35], v[34:35], v[182:183]
    v_cvt_pk_bf16_f32 v128, v28, v29
    v_cvt_pk_bf16_f32 v129, v30, v31
    v_cvt_pk_bf16_f32 v130, v32, v33
    v_cvt_pk_bf16_f32 v131, v34, v35
    ds_write_b128 v181, v[128:131] offset:128
    v_pk_mul_f32 v[36:37], v[36:37], v[182:183]
    s_add_u32 m0, s27, 65536
    s_mov_b32 s28, 0x69380
    buffer_load_dwordx4 v184, s[16:19], s28 offen lds
    v_pk_mul_f32 v[38:39], v[38:39], v[182:183]
    v_pk_mul_f32 v[40:41], v[40:41], v[182:183]
    v_pk_mul_f32 v[42:43], v[42:43], v[182:183]
    v_cvt_pk_bf16_f32 v132, v36, v37
    v_cvt_pk_bf16_f32 v133, v38, v39
    v_cvt_pk_bf16_f32 v134, v40, v41
    v_cvt_pk_bf16_f32 v135, v42, v43
    ds_write_b128 v180, v[132:135] offset:256
    v_pk_mul_f32 v[44:45], v[44:45], v[182:183]
    v_pk_mul_f32 v[46:47], v[46:47], v[182:183]
    v_pk_mul_f32 v[48:49], v[48:49], v[182:183]
    v_pk_mul_f32 v[50:51], v[50:51], v[182:183]
    s_add_u32 m0, s27, 69632
    s_mov_b32 s28, 0x69700
    buffer_load_dwordx4 v184, s[16:19], s28 offen lds
    v_cvt_pk_bf16_f32 v136, v44, v45
    v_cvt_pk_bf16_f32 v137, v46, v47
    v_cvt_pk_bf16_f32 v138, v48, v49
    v_cvt_pk_bf16_f32 v139, v50, v51
    ds_write_b128 v181, v[136:139] offset:256
    v_pk_mul_f32 v[52:53], v[52:53], v[182:183]
    v_pk_mul_f32 v[54:55], v[54:55], v[182:183]
    v_pk_mul_f32 v[56:57], v[56:57], v[182:183]
    v_pk_mul_f32 v[58:59], v[58:59], v[182:183]
    v_cvt_pk_bf16_f32 v140, v52, v53
    v_cvt_pk_bf16_f32 v141, v54, v55
    s_add_u32 m0, s27, 73728
    s_mov_b32 s28, 0x7e000
    buffer_load_dwordx4 v184, s[16:19], s28 offen lds
    v_cvt_pk_bf16_f32 v142, v56, v57
    v_cvt_pk_bf16_f32 v143, v58, v59
    ds_write_b128 v180, v[140:143] offset:384
    v_pk_mul_f32 v[60:61], v[60:61], v[182:183]
    v_pk_mul_f32 v[62:63], v[62:63], v[182:183]
    v_pk_mul_f32 v[64:65], v[64:65], v[182:183]
    v_pk_mul_f32 v[66:67], v[66:67], v[182:183]
    v_cvt_pk_bf16_f32 v144, v60, v61
    v_cvt_pk_bf16_f32 v145, v62, v63
    v_cvt_pk_bf16_f32 v146, v64, v65
    v_cvt_pk_bf16_f32 v147, v66, v67
    s_add_u32 m0, s27, 77824
    s_mov_b32 s28, 0x7e380
    buffer_load_dwordx4 v184, s[16:19], s28 offen lds
    ds_write_b128 v181, v[144:147] offset:384
    v_pk_mul_f32 v[68:69], v[68:69], v[182:183]
    v_pk_mul_f32 v[70:71], v[70:71], v[182:183]
    v_pk_mul_f32 v[72:73], v[72:73], v[182:183]
    v_pk_mul_f32 v[74:75], v[74:75], v[182:183]
    v_cvt_pk_bf16_f32 v148, v68, v69
    v_cvt_pk_bf16_f32 v149, v70, v71
    v_cvt_pk_bf16_f32 v150, v72, v73
    v_cvt_pk_bf16_f32 v151, v74, v75
    ds_write_b128 v180, v[148:151] offset:512
    v_pk_mul_f32 v[76:77], v[76:77], v[182:183]
    s_add_u32 m0, s27, 81920
    s_mov_b32 s28, 0x7e700
    buffer_load_dwordx4 v184, s[16:19], s28 offen lds
    v_pk_mul_f32 v[78:79], v[78:79], v[182:183]
    v_pk_mul_f32 v[80:81], v[80:81], v[182:183]
    v_pk_mul_f32 v[82:83], v[82:83], v[182:183]
    v_cvt_pk_bf16_f32 v152, v76, v77
    v_cvt_pk_bf16_f32 v153, v78, v79
    v_cvt_pk_bf16_f32 v154, v80, v81
    v_cvt_pk_bf16_f32 v155, v82, v83
    ds_write_b128 v181, v[152:155] offset:512
    v_pk_mul_f32 v[84:85], v[84:85], v[182:183]
    v_pk_mul_f32 v[86:87], v[86:87], v[182:183]
    v_pk_mul_f32 v[88:89], v[88:89], v[182:183]
    s_add_u32 m0, s27, 86016
    s_mov_b32 s28, 0x93000
    buffer_load_dwordx4 v184, s[16:19], s28 offen lds
    v_pk_mul_f32 v[90:91], v[90:91], v[182:183]
    v_cvt_pk_bf16_f32 v156, v84, v85
    v_cvt_pk_bf16_f32 v157, v86, v87
    v_cvt_pk_bf16_f32 v158, v88, v89
    v_cvt_pk_bf16_f32 v159, v90, v91
    ds_write_b128 v180, v[156:159] offset:640
    v_pk_mul_f32 v[92:93], v[92:93], v[182:183]
    v_pk_mul_f32 v[94:95], v[94:95], v[182:183]
    v_pk_mul_f32 v[96:97], v[96:97], v[182:183]
    v_pk_mul_f32 v[98:99], v[98:99], v[182:183]
    v_cvt_pk_bf16_f32 v160, v92, v93
    s_add_u32 m0, s27, 90112
    s_mov_b32 s28, 0x93380
    buffer_load_dwordx4 v184, s[16:19], s28 offen lds
    v_cvt_pk_bf16_f32 v161, v94, v95
    v_cvt_pk_bf16_f32 v162, v96, v97
    v_cvt_pk_bf16_f32 v163, v98, v99
    ds_write_b128 v181, v[160:163] offset:640
    v_pk_mul_f32 v[100:101], v[100:101], v[182:183]
    v_pk_mul_f32 v[102:103], v[102:103], v[182:183]
    v_pk_mul_f32 v[104:105], v[104:105], v[182:183]
    v_pk_mul_f32 v[106:107], v[106:107], v[182:183]
    v_cvt_pk_bf16_f32 v164, v100, v101
    v_cvt_pk_bf16_f32 v165, v102, v103
    v_cvt_pk_bf16_f32 v166, v104, v105
    s_add_u32 m0, s27, 94208
    s_mov_b32 s28, 0x93700
    buffer_load_dwordx4 v184, s[16:19], s28 offen lds
    v_cvt_pk_bf16_f32 v167, v106, v107
    ds_write_b128 v180, v[164:167] offset:768
    v_pk_mul_f32 v[108:109], v[108:109], v[182:183]
    v_pk_mul_f32 v[110:111], v[110:111], v[182:183]
    v_pk_mul_f32 v[112:113], v[112:113], v[182:183]
    v_pk_mul_f32 v[114:115], v[114:115], v[182:183]
    v_cvt_pk_bf16_f32 v168, v108, v109
    v_cvt_pk_bf16_f32 v169, v110, v111
    v_cvt_pk_bf16_f32 v170, v112, v113
    v_cvt_pk_bf16_f32 v171, v114, v115
    ds_write_b128 v181, v[168:171] offset:768
    v_and_b32 v10, 31, v2
    v_lshrrev_b32 v11, 5, v2
    v_lshrrev_b32 v12, 1, v10
    v_and_b32 v12, 7, v12
    v_xor_b32 v11, v11, v12
    v_mul_u32_u24 v10, 0x380, v10
    v_lshl_add_u32 v4, v11, 4, v10
    v_add_u32 v4, 0x18000, v4
    v_xor_b32 v5, 32, v4
    v_xor_b32 v6, 64, v4
    v_xor_b32 v7, 96, v4
    s_and_b32 s29, s22, 1
    s_mul_i32 s29, s29, 0x7000
    v_add_u32 v4, s29, v4
    v_add_u32 v5, s29, v5
    v_add_u32 v6, s29, v6
    v_add_u32 v7, s29, v7
    v_lshrrev_b32 v10, 4, v2
    v_and_b32 v11, 1, v10
    v_lshrrev_b32 v12, 1, v10
    v_lshrrev_b32 v13, 2, v2
    v_and_b32 v13, 3, v13
    v_and_b32 v14, 3, v2
    v_lshlrev_b32 v15, 5, v11
    v_lshl_add_u32 v15, v14, 3, v15
    s_lshr_b32 s30, s22, 1
    s_mul_i32 s30, s30, 56
    v_add_u32 v15, s30, v15
    v_lshrrev_b32 v16, 1, v13
    v_lshlrev_b32 v16, 6, v16
    v_xor_b32 v15, v16, v15
    v_lshl_add_u32 v17, v12, 3, v13
    v_lshl_add_u32 v8, v17, 7, v15
    v_add_u32 v9, 0xc000, v8
    s_waitcnt vmcnt(21) lgkmcnt(0)
    s_barrier
    ds_read_b128 v[68:71], v4 offset:0
    ds_read_b64_tr_b16 v[76:77], v8 offset:0
    ds_read_b64_tr_b16 v[78:79], v8 offset:512
    ds_read_b64_tr_b16 v[80:81], v8 offset:4096
    ds_read_b64_tr_b16 v[82:83], v8 offset:4608
    ds_read_b64_tr_b16 v[84:85], v8 offset:8192
    ds_read_b64_tr_b16 v[86:87], v8 offset:8704
    ds_read_b128 v[72:75], v5 offset:0
    ds_read_b64_tr_b16 v[88:89], v8 offset:2048
    ds_read_b64_tr_b16 v[90:91], v8 offset:2560
    ds_read_b64_tr_b16 v[92:93], v8 offset:6144
    ds_read_b64_tr_b16 v[94:95], v8 offset:6656
    ds_read_b64_tr_b16 v[96:97], v8 offset:10240
    ds_read_b64_tr_b16 v[98:99], v8 offset:10752
    s_waitcnt vmcnt(18) lgkmcnt(0)
    s_barrier
    v_mfma_f32_32x32x16_bf16 v[20:35], v[76:79], v[68:71], 0
    s_add_u32 m0, s27, 0
    s_mov_b32 s28, 0xa8000
    buffer_load_dwordx4 v184, s[16:19], s28 offen lds
    s_add_u32 m0, s27, 4096
    s_mov_b32 s28, 0xa8380
    buffer_load_dwordx4 v184, s[16:19], s28 offen lds
    s_add_u32 m0, s27, 8192
    s_mov_b32 s28, 0xa8700
    buffer_load_dwordx4 v184, s[16:19], s28 offen lds
    v_mfma_f32_32x32x16_bf16 v[36:51], v[80:83], v[68:71], 0
    ds_read_b128 v[100:103], v6 offset:0
    ds_read_b64_tr_b16 v[108:109], v8 offset:12288
    ds_read_b64_tr_b16 v[110:111], v8 offset:12800
    ds_read_b64_tr_b16 v[112:113], v8 offset:16384
    v_mfma_f32_32x32x16_bf16 v[52:67], v[68:71], v[84:87], 0
    ds_read_b64_tr_b16 v[114:115], v8 offset:16896
    ds_read_b64_tr_b16 v[116:117], v8 offset:20480
    ds_read_b64_tr_b16 v[118:119], v8 offset:20992
    ds_read_b128 v[104:107], v7 offset:0
    v_mfma_f32_32x32x16_bf16 v[20:35], v[88:91], v[72:75], v[20:35]
    ds_read_b64_tr_b16 v[120:121], v8 offset:14336
    ds_read_b64_tr_b16 v[122:123], v8 offset:14848
    ds_read_b64_tr_b16 v[124:125], v8 offset:18432
    v_mfma_f32_32x32x16_bf16 v[36:51], v[92:95], v[72:75], v[36:51]
    ds_read_b64_tr_b16 v[126:127], v8 offset:18944
    ds_read_b64_tr_b16 v[128:129], v8 offset:22528
    ds_read_b64_tr_b16 v[130:131], v8 offset:23040
    v_mfma_f32_32x32x16_bf16 v[52:67], v[72:75], v[96:99], v[52:67]
    s_waitcnt vmcnt(18) lgkmcnt(0)
    s_barrier
    v_mfma_f32_32x32x16_bf16 v[20:35], v[108:111], v[100:103], v[20:35]
    s_add_u32 m0, s27, 12288
    s_mov_b32 s28, 0xbd000
    buffer_load_dwordx4 v184, s[16:19], s28 offen lds
    s_add_u32 m0, s27, 16384
    s_mov_b32 s28, 0xbd380
    buffer_load_dwordx4 v184, s[16:19], s28 offen lds
    s_add_u32 m0, s27, 20480
    s_mov_b32 s28, 0xbd700
    buffer_load_dwordx4 v184, s[16:19], s28 offen lds
    v_mfma_f32_32x32x16_bf16 v[36:51], v[112:115], v[100:103], v[36:51]
    ds_read_b128 v[68:71], v4 offset:128
    ds_read_b64_tr_b16 v[76:77], v8 offset:24576
    ds_read_b64_tr_b16 v[78:79], v8 offset:25088
    ds_read_b64_tr_b16 v[80:81], v8 offset:28672
    v_mfma_f32_32x32x16_bf16 v[52:67], v[100:103], v[116:119], v[52:67]
    ds_read_b64_tr_b16 v[82:83], v8 offset:29184
    ds_read_b64_tr_b16 v[84:85], v8 offset:32768
    ds_read_b64_tr_b16 v[86:87], v8 offset:33280
    ds_read_b128 v[72:75], v5 offset:128
    v_mfma_f32_32x32x16_bf16 v[20:35], v[120:123], v[104:107], v[20:35]
    ds_read_b64_tr_b16 v[88:89], v8 offset:26624
    ds_read_b64_tr_b16 v[90:91], v8 offset:27136
    ds_read_b64_tr_b16 v[92:93], v8 offset:30720
    v_mfma_f32_32x32x16_bf16 v[36:51], v[124:127], v[104:107], v[36:51]
    ds_read_b64_tr_b16 v[94:95], v8 offset:31232
    ds_read_b64_tr_b16 v[96:97], v8 offset:34816
    ds_read_b64_tr_b16 v[98:99], v8 offset:35328
    v_mfma_f32_32x32x16_bf16 v[52:67], v[104:107], v[128:131], v[52:67]
    s_waitcnt vmcnt(18) lgkmcnt(0)
    s_barrier
    v_mfma_f32_32x32x16_bf16 v[20:35], v[76:79], v[68:71], v[20:35]
    s_add_u32 m0, s27, 24576
    s_mov_b32 s28, 0xd2000
    buffer_load_dwordx4 v184, s[16:19], s28 offen lds
    s_add_u32 m0, s27, 28672
    s_mov_b32 s28, 0xd2380
    buffer_load_dwordx4 v184, s[16:19], s28 offen lds
    s_add_u32 m0, s27, 32768
    s_mov_b32 s28, 0xd2700
    buffer_load_dwordx4 v184, s[16:19], s28 offen lds
    v_mfma_f32_32x32x16_bf16 v[36:51], v[80:83], v[68:71], v[36:51]
    ds_read_b128 v[100:103], v6 offset:128
    ds_read_b64_tr_b16 v[108:109], v8 offset:36864
    ds_read_b64_tr_b16 v[110:111], v8 offset:37376
    ds_read_b64_tr_b16 v[112:113], v8 offset:40960
    v_mfma_f32_32x32x16_bf16 v[52:67], v[68:71], v[84:87], v[52:67]
    ds_read_b64_tr_b16 v[114:115], v8 offset:41472
    ds_read_b64_tr_b16 v[116:117], v8 offset:45056
    ds_read_b64_tr_b16 v[118:119], v8 offset:45568
    ds_read_b128 v[104:107], v7 offset:128
    v_mfma_f32_32x32x16_bf16 v[20:35], v[88:91], v[72:75], v[20:35]
    ds_read_b64_tr_b16 v[120:121], v8 offset:38912
    ds_read_b64_tr_b16 v[122:123], v8 offset:39424
    ds_read_b64_tr_b16 v[124:125], v8 offset:43008
    v_mfma_f32_32x32x16_bf16 v[36:51], v[92:95], v[72:75], v[36:51]
    ds_read_b64_tr_b16 v[126:127], v8 offset:43520
    ds_read_b64_tr_b16 v[128:129], v8 offset:47104
    ds_read_b64_tr_b16 v[130:131], v8 offset:47616
    v_mfma_f32_32x32x16_bf16 v[52:67], v[72:75], v[96:99], v[52:67]
    s_waitcnt vmcnt(18) lgkmcnt(0)
    s_barrier
    v_mfma_f32_32x32x16_bf16 v[20:35], v[108:111], v[100:103], v[20:35]
    s_add_u32 m0, s27, 36864
    s_mov_b32 s28, 0xe7000
    buffer_load_dwordx4 v184, s[16:19], s28 offen lds
    s_add_u32 m0, s27, 40960
    s_mov_b32 s28, 0xe7380
    buffer_load_dwordx4 v184, s[16:19], s28 offen lds
    s_add_u32 m0, s27, 45056
    s_mov_b32 s28, 0xe7700
    buffer_load_dwordx4 v184, s[16:19], s28 offen lds
    v_mfma_f32_32x32x16_bf16 v[36:51], v[112:115], v[100:103], v[36:51]
    ds_read_b128 v[68:71], v4 offset:256
    ds_read_b64_tr_b16 v[76:77], v9 offset:0
    ds_read_b64_tr_b16 v[78:79], v9 offset:512
    ds_read_b64_tr_b16 v[80:81], v9 offset:4096
    v_mfma_f32_32x32x16_bf16 v[52:67], v[100:103], v[116:119], v[52:67]
    ds_read_b64_tr_b16 v[82:83], v9 offset:4608
    ds_read_b64_tr_b16 v[84:85], v9 offset:8192
    ds_read_b64_tr_b16 v[86:87], v9 offset:8704
    ds_read_b128 v[72:75], v5 offset:256
    v_mfma_f32_32x32x16_bf16 v[20:35], v[120:123], v[104:107], v[20:35]
    ds_read_b64_tr_b16 v[88:89], v9 offset:2048
    ds_read_b64_tr_b16 v[90:91], v9 offset:2560
    ds_read_b64_tr_b16 v[92:93], v9 offset:6144
    v_mfma_f32_32x32x16_bf16 v[36:51], v[124:127], v[104:107], v[36:51]
    ds_read_b64_tr_b16 v[94:95], v9 offset:6656
    ds_read_b64_tr_b16 v[96:97], v9 offset:10240
    ds_read_b64_tr_b16 v[98:99], v9 offset:10752
    v_mfma_f32_32x32x16_bf16 v[52:67], v[104:107], v[128:131], v[52:67]
    s_waitcnt vmcnt(18) lgkmcnt(0)
    s_barrier
    v_mfma_f32_32x32x16_bf16 v[20:35], v[76:79], v[68:71], v[20:35]
    s_add_u32 m0, s27, 49152
    s_mov_b32 s28, 0xfc000
    buffer_load_dwordx4 v184, s[16:19], s28 offen lds
    s_add_u32 m0, s27, 53248
    s_mov_b32 s28, 0xfc380
    buffer_load_dwordx4 v184, s[16:19], s28 offen lds
    s_add_u32 m0, s27, 57344
    s_mov_b32 s28, 0xfc700
    buffer_load_dwordx4 v184, s[16:19], s28 offen lds
    v_mfma_f32_32x32x16_bf16 v[36:51], v[80:83], v[68:71], v[36:51]
    ds_read_b128 v[100:103], v6 offset:256
    ds_read_b64_tr_b16 v[108:109], v9 offset:12288
    ds_read_b64_tr_b16 v[110:111], v9 offset:12800
    ds_read_b64_tr_b16 v[112:113], v9 offset:16384
    v_mfma_f32_32x32x16_bf16 v[52:67], v[68:71], v[84:87], v[52:67]
    ds_read_b64_tr_b16 v[114:115], v9 offset:16896
    ds_read_b64_tr_b16 v[116:117], v9 offset:20480
    ds_read_b64_tr_b16 v[118:119], v9 offset:20992
    ds_read_b128 v[104:107], v7 offset:256
    v_mfma_f32_32x32x16_bf16 v[20:35], v[88:91], v[72:75], v[20:35]
    ds_read_b64_tr_b16 v[120:121], v9 offset:14336
    ds_read_b64_tr_b16 v[122:123], v9 offset:14848
    ds_read_b64_tr_b16 v[124:125], v9 offset:18432
    v_mfma_f32_32x32x16_bf16 v[36:51], v[92:95], v[72:75], v[36:51]
    ds_read_b64_tr_b16 v[126:127], v9 offset:18944
    ds_read_b64_tr_b16 v[128:129], v9 offset:22528
    ds_read_b64_tr_b16 v[130:131], v9 offset:23040
    v_mfma_f32_32x32x16_bf16 v[52:67], v[72:75], v[96:99], v[52:67]
    s_waitcnt vmcnt(18) lgkmcnt(0)
    s_barrier
    v_mfma_f32_32x32x16_bf16 v[20:35], v[108:111], v[100:103], v[20:35]
    s_add_u32 m0, s27, 61440
    s_mov_b32 s28, 0x111000
    buffer_load_dwordx4 v184, s[16:19], s28 offen lds
    s_add_u32 m0, s27, 65536
    s_mov_b32 s28, 0x111380
    buffer_load_dwordx4 v184, s[16:19], s28 offen lds
    s_add_u32 m0, s27, 69632
    s_mov_b32 s28, 0x111700
    buffer_load_dwordx4 v184, s[16:19], s28 offen lds
    v_mfma_f32_32x32x16_bf16 v[36:51], v[112:115], v[100:103], v[36:51]
    ds_read_b128 v[68:71], v4 offset:384
    ds_read_b64_tr_b16 v[76:77], v9 offset:24576
    ds_read_b64_tr_b16 v[78:79], v9 offset:25088
    ds_read_b64_tr_b16 v[80:81], v9 offset:28672
    v_mfma_f32_32x32x16_bf16 v[52:67], v[100:103], v[116:119], v[52:67]
    ds_read_b64_tr_b16 v[82:83], v9 offset:29184
    ds_read_b64_tr_b16 v[84:85], v9 offset:32768
    ds_read_b64_tr_b16 v[86:87], v9 offset:33280
    ds_read_b128 v[72:75], v5 offset:384
    v_mfma_f32_32x32x16_bf16 v[20:35], v[120:123], v[104:107], v[20:35]
    ds_read_b64_tr_b16 v[88:89], v9 offset:26624
    ds_read_b64_tr_b16 v[90:91], v9 offset:27136
    ds_read_b64_tr_b16 v[92:93], v9 offset:30720
    v_mfma_f32_32x32x16_bf16 v[36:51], v[124:127], v[104:107], v[36:51]
    ds_read_b64_tr_b16 v[94:95], v9 offset:31232
    ds_read_b64_tr_b16 v[96:97], v9 offset:34816
    ds_read_b64_tr_b16 v[98:99], v9 offset:35328
    v_mfma_f32_32x32x16_bf16 v[52:67], v[104:107], v[128:131], v[52:67]
    s_waitcnt vmcnt(18) lgkmcnt(0)
    s_barrier
    v_mfma_f32_32x32x16_bf16 v[20:35], v[76:79], v[68:71], v[20:35]
    v_mfma_f32_32x32x16_bf16 v[36:51], v[80:83], v[68:71], v[36:51]
    ds_read_b128 v[100:103], v6 offset:384
    ds_read_b64_tr_b16 v[108:109], v9 offset:36864
    ds_read_b64_tr_b16 v[110:111], v9 offset:37376
    ds_read_b64_tr_b16 v[112:113], v9 offset:40960
    v_mfma_f32_32x32x16_bf16 v[52:67], v[68:71], v[84:87], v[52:67]
    ds_read_b64_tr_b16 v[114:115], v9 offset:41472
    ds_read_b64_tr_b16 v[116:117], v9 offset:45056
    ds_read_b64_tr_b16 v[118:119], v9 offset:45568
    ds_read_b128 v[104:107], v7 offset:384
    v_mfma_f32_32x32x16_bf16 v[20:35], v[88:91], v[72:75], v[20:35]
    ds_read_b64_tr_b16 v[120:121], v9 offset:38912
    ds_read_b64_tr_b16 v[122:123], v9 offset:39424
    ds_read_b64_tr_b16 v[124:125], v9 offset:43008
    v_mfma_f32_32x32x16_bf16 v[36:51], v[92:95], v[72:75], v[36:51]
    ds_read_b64_tr_b16 v[126:127], v9 offset:43520
    ds_read_b64_tr_b16 v[128:129], v9 offset:47104
    ds_read_b64_tr_b16 v[130:131], v9 offset:47616
    v_mfma_f32_32x32x16_bf16 v[52:67], v[72:75], v[96:99], v[52:67]
    s_waitcnt vmcnt(15) lgkmcnt(0)
    s_barrier
    v_mfma_f32_32x32x16_bf16 v[20:35], v[108:111], v[100:103], v[20:35]
    v_mfma_f32_32x32x16_bf16 v[36:51], v[112:115], v[100:103], v[36:51]
    ds_read_b128 v[68:71], v4 offset:512
    ds_read_b64_tr_b16 v[76:77], v8 offset:0
    ds_read_b64_tr_b16 v[78:79], v8 offset:512
    ds_read_b64_tr_b16 v[80:81], v8 offset:4096
    v_mfma_f32_32x32x16_bf16 v[52:67], v[100:103], v[116:119], v[52:67]
    ds_read_b64_tr_b16 v[82:83], v8 offset:4608
    ds_read_b64_tr_b16 v[84:85], v8 offset:8192
    ds_read_b64_tr_b16 v[86:87], v8 offset:8704
    ds_read_b128 v[72:75], v5 offset:512
    v_mfma_f32_32x32x16_bf16 v[20:35], v[120:123], v[104:107], v[20:35]
    ds_read_b64_tr_b16 v[88:89], v8 offset:2048
    ds_read_b64_tr_b16 v[90:91], v8 offset:2560
    ds_read_b64_tr_b16 v[92:93], v8 offset:6144
    v_mfma_f32_32x32x16_bf16 v[36:51], v[124:127], v[104:107], v[36:51]
    ds_read_b64_tr_b16 v[94:95], v8 offset:6656
    ds_read_b64_tr_b16 v[96:97], v8 offset:10240
    ds_read_b64_tr_b16 v[98:99], v8 offset:10752
    v_mfma_f32_32x32x16_bf16 v[52:67], v[104:107], v[128:131], v[52:67]
    s_waitcnt vmcnt(12) lgkmcnt(0)
    s_barrier
    v_mfma_f32_32x32x16_bf16 v[20:35], v[76:79], v[68:71], v[20:35]
    v_mfma_f32_32x32x16_bf16 v[36:51], v[80:83], v[68:71], v[36:51]
    ds_read_b128 v[100:103], v6 offset:512
    ds_read_b64_tr_b16 v[108:109], v8 offset:12288
    ds_read_b64_tr_b16 v[110:111], v8 offset:12800
    ds_read_b64_tr_b16 v[112:113], v8 offset:16384
    v_mfma_f32_32x32x16_bf16 v[52:67], v[68:71], v[84:87], v[52:67]
    ds_read_b64_tr_b16 v[114:115], v8 offset:16896
    ds_read_b64_tr_b16 v[116:117], v8 offset:20480
    ds_read_b64_tr_b16 v[118:119], v8 offset:20992
    ds_read_b128 v[104:107], v7 offset:512
    v_mfma_f32_32x32x16_bf16 v[20:35], v[88:91], v[72:75], v[20:35]
    ds_read_b64_tr_b16 v[120:121], v8 offset:14336
    ds_read_b64_tr_b16 v[122:123], v8 offset:14848
    ds_read_b64_tr_b16 v[124:125], v8 offset:18432
    v_mfma_f32_32x32x16_bf16 v[36:51], v[92:95], v[72:75], v[36:51]
    ds_read_b64_tr_b16 v[126:127], v8 offset:18944
    ds_read_b64_tr_b16 v[128:129], v8 offset:22528
    ds_read_b64_tr_b16 v[130:131], v8 offset:23040
    v_mfma_f32_32x32x16_bf16 v[52:67], v[72:75], v[96:99], v[52:67]
    s_waitcnt vmcnt(9) lgkmcnt(0)
    s_barrier
    v_mfma_f32_32x32x16_bf16 v[20:35], v[108:111], v[100:103], v[20:35]
    v_mfma_f32_32x32x16_bf16 v[36:51], v[112:115], v[100:103], v[36:51]
    ds_read_b128 v[68:71], v4 offset:640
    ds_read_b64_tr_b16 v[76:77], v8 offset:24576
    ds_read_b64_tr_b16 v[78:79], v8 offset:25088
    ds_read_b64_tr_b16 v[80:81], v8 offset:28672
    v_mfma_f32_32x32x16_bf16 v[52:67], v[100:103], v[116:119], v[52:67]
    ds_read_b64_tr_b16 v[82:83], v8 offset:29184
    ds_read_b64_tr_b16 v[84:85], v8 offset:32768
    ds_read_b64_tr_b16 v[86:87], v8 offset:33280
    ds_read_b128 v[72:75], v5 offset:640
    v_mfma_f32_32x32x16_bf16 v[20:35], v[120:123], v[104:107], v[20:35]
    ds_read_b64_tr_b16 v[88:89], v8 offset:26624
    ds_read_b64_tr_b16 v[90:91], v8 offset:27136
    ds_read_b64_tr_b16 v[92:93], v8 offset:30720
    v_mfma_f32_32x32x16_bf16 v[36:51], v[124:127], v[104:107], v[36:51]
    ds_read_b64_tr_b16 v[94:95], v8 offset:31232
    ds_read_b64_tr_b16 v[96:97], v8 offset:34816
    ds_read_b64_tr_b16 v[98:99], v8 offset:35328
    v_mfma_f32_32x32x16_bf16 v[52:67], v[104:107], v[128:131], v[52:67]
    s_waitcnt vmcnt(6) lgkmcnt(0)
    s_barrier
    v_mfma_f32_32x32x16_bf16 v[20:35], v[76:79], v[68:71], v[20:35]
    v_mfma_f32_32x32x16_bf16 v[36:51], v[80:83], v[68:71], v[36:51]
    ds_read_b128 v[100:103], v6 offset:640
    ds_read_b64_tr_b16 v[108:109], v8 offset:36864
    ds_read_b64_tr_b16 v[110:111], v8 offset:37376
    ds_read_b64_tr_b16 v[112:113], v8 offset:40960
    v_mfma_f32_32x32x16_bf16 v[52:67], v[68:71], v[84:87], v[52:67]
    ds_read_b64_tr_b16 v[114:115], v8 offset:41472
    ds_read_b64_tr_b16 v[116:117], v8 offset:45056
    ds_read_b64_tr_b16 v[118:119], v8 offset:45568
    ds_read_b128 v[104:107], v7 offset:640
    v_mfma_f32_32x32x16_bf16 v[20:35], v[88:91], v[72:75], v[20:35]
    ds_read_b64_tr_b16 v[120:121], v8 offset:38912
    ds_read_b64_tr_b16 v[122:123], v8 offset:39424
    ds_read_b64_tr_b16 v[124:125], v8 offset:43008
    v_mfma_f32_32x32x16_bf16 v[36:51], v[92:95], v[72:75], v[36:51]
    ds_read_b64_tr_b16 v[126:127], v8 offset:43520
    ds_read_b64_tr_b16 v[128:129], v8 offset:47104
    ds_read_b64_tr_b16 v[130:131], v8 offset:47616
    v_mfma_f32_32x32x16_bf16 v[52:67], v[72:75], v[96:99], v[52:67]
    s_waitcnt vmcnt(3) lgkmcnt(0)
    s_barrier
    v_mfma_f32_32x32x16_bf16 v[20:35], v[108:111], v[100:103], v[20:35]
    v_mfma_f32_32x32x16_bf16 v[36:51], v[112:115], v[100:103], v[36:51]
    ds_read_b128 v[68:71], v4 offset:768
    ds_read_b64_tr_b16 v[76:77], v9 offset:0
    ds_read_b64_tr_b16 v[78:79], v9 offset:512
    ds_read_b64_tr_b16 v[80:81], v9 offset:4096
    v_mfma_f32_32x32x16_bf16 v[52:67], v[100:103], v[116:119], v[52:67]
    ds_read_b64_tr_b16 v[82:83], v9 offset:4608
    ds_read_b64_tr_b16 v[84:85], v9 offset:8192
    ds_read_b64_tr_b16 v[86:87], v9 offset:8704
    ds_read_b128 v[72:75], v5 offset:768
    v_mfma_f32_32x32x16_bf16 v[20:35], v[120:123], v[104:107], v[20:35]
    ds_read_b64_tr_b16 v[88:89], v9 offset:2048
    ds_read_b64_tr_b16 v[90:91], v9 offset:2560
    ds_read_b64_tr_b16 v[92:93], v9 offset:6144
    v_mfma_f32_32x32x16_bf16 v[36:51], v[124:127], v[104:107], v[36:51]
    ds_read_b64_tr_b16 v[94:95], v9 offset:6656
    ds_read_b64_tr_b16 v[96:97], v9 offset:10240
    ds_read_b64_tr_b16 v[98:99], v9 offset:10752
    v_mfma_f32_32x32x16_bf16 v[52:67], v[104:107], v[128:131], v[52:67]
    s_waitcnt vmcnt(0) lgkmcnt(0)
    s_barrier
    v_mfma_f32_32x32x16_bf16 v[20:35], v[76:79], v[68:71], v[20:35]
    v_mfma_f32_32x32x16_bf16 v[36:51], v[80:83], v[68:71], v[36:51]
    ds_read_b128 v[100:103], v6 offset:768
    ds_read_b64_tr_b16 v[108:109], v9 offset:12288
    ds_read_b64_tr_b16 v[110:111], v9 offset:12800
    ds_read_b64_tr_b16 v[112:113], v9 offset:16384
    v_mfma_f32_32x32x16_bf16 v[52:67], v[68:71], v[84:87], v[52:67]
    ds_read_b64_tr_b16 v[114:115], v9 offset:16896
    ds_read_b64_tr_b16 v[116:117], v9 offset:20480
    ds_read_b64_tr_b16 v[118:119], v9 offset:20992
    ds_read_b128 v[104:107], v7 offset:768
    v_mfma_f32_32x32x16_bf16 v[20:35], v[88:91], v[72:75], v[20:35]
    ds_read_b64_tr_b16 v[120:121], v9 offset:14336
    ds_read_b64_tr_b16 v[122:123], v9 offset:14848
    ds_read_b64_tr_b16 v[124:125], v9 offset:18432
    v_mfma_f32_32x32x16_bf16 v[36:51], v[92:95], v[72:75], v[36:51]
    ds_read_b64_tr_b16 v[126:127], v9 offset:18944
    ds_read_b64_tr_b16 v[128:129], v9 offset:22528
    ds_read_b64_tr_b16 v[130:131], v9 offset:23040
    v_mfma_f32_32x32x16_bf16 v[52:67], v[72:75], v[96:99], v[52:67]
    s_waitcnt lgkmcnt(0)
    v_mfma_f32_32x32x16_bf16 v[20:35], v[108:111], v[100:103], v[20:35]
    v_mfma_f32_32x32x16_bf16 v[36:51], v[112:115], v[100:103], v[36:51]
    v_mfma_f32_32x32x16_bf16 v[52:67], v[100:103], v[116:119], v[52:67]
    v_mfma_f32_32x32x16_bf16 v[20:35], v[120:123], v[104:107], v[20:35]
    v_mfma_f32_32x32x16_bf16 v[36:51], v[124:127], v[104:107], v[36:51]
    v_mfma_f32_32x32x16_bf16 v[52:67], v[104:107], v[128:131], v[52:67]
    s_nop 15
    s_nop 7
    s_mov_b32 s32, 0
    s_mov_b32 s33, -1
    s_mov_b32 s34, 0xf0000000
    s_mov_b32 s35, 0xf0000000
    v_and_b32 v10, 31, v2
    v_mov_b32 v11, 0x3f803f80
    v_cmp_eq_u32 vcc, 28, v10
    s_nop 1
    v_cndmask_b32 v11, 0, v11, vcc
    s_mov_b32 s36, 0x3e8b97f6
    v_mul_f32 v20, s36, v20
    v_mul_f32 v21, s36, v21
    v_mul_f32 v22, s36, v22
    v_mul_f32 v23, s36, v23
    v_mul_f32 v24, s36, v24
    v_mul_f32 v25, s36, v25
    v_mul_f32 v26, s36, v26
    v_mul_f32 v27, s36, v27
    v_mul_f32 v28, s36, v28
    v_mul_f32 v29, s36, v29
    v_mul_f32 v30, s36, v30
    v_mul_f32 v31, s36, v31
    v_mul_f32 v32, s36, v32
    v_mul_f32 v33, s36, v33
    v_mul_f32 v34, s36, v34
    v_mul_f32 v35, s36, v35
    v_cvt_pk_bf16_f32 v68, v20, v21
    v_cvt_pk_bf16_f32 v69, v22, v23
    v_cvt_pk_bf16_f32 v70, v24, v25
    v_cvt_pk_bf16_f32 v71, v26, v27
    v_cvt_pk_bf16_f32 v72, v28, v29
    v_cvt_pk_bf16_f32 v73, v30, v31
    v_cvt_pk_bf16_f32 v74, v32, v33
    v_cvt_pk_bf16_f32 v75, v34, v35
    v_cvt_pk_bf16_f32 v76, v36, v37
    v_cvt_pk_bf16_f32 v77, v38, v39
    v_cvt_pk_bf16_f32 v78, v40, v41
    v_cvt_pk_bf16_f32 v79, v42, v43
    v_cvt_pk_bf16_f32 v80, v44, v45
    v_cvt_pk_bf16_f32 v81, v46, v47
    v_cvt_pk_bf16_f32 v82, v48, v49
    v_cvt_pk_bf16_f32 v83, v50, v51
    v_cvt_pk_bf16_f32 v84, v52, v53
    v_cvt_pk_bf16_f32 v85, v54, v55
    v_cvt_pk_bf16_f32 v86, v56, v57
    v_cvt_pk_bf16_f32 v87, v58, v59
    v_cvt_pk_bf16_f32 v88, v60, v61
    v_cvt_pk_bf16_f32 v89, v62, v63
    v_cvt_pk_bf16_f32 v90, v64, v65
    v_cvt_pk_bf16_f32 v91, v66, v67
    v_mov_b32 v12, 0x3f80
    v_cndmask_b32_e64 v74, v74, 0, s[32:33]
    v_cndmask_b32_e64 v75, v75, 0, s[32:33]
    v_cndmask_b32_e64 v82, v82, v12, s[32:33]
    v_cndmask_b32_e64 v83, v83, 0, s[32:33]
    v_cndmask_b32_e64 v84, v84, v11, s[34:35]
    v_cndmask_b32_e64 v85, v85, v11, s[34:35]
    v_cndmask_b32_e64 v86, v86, v11, s[34:35]
    v_cndmask_b32_e64 v87, v87, v11, s[34:35]
    v_cndmask_b32_e64 v88, v88, v11, s[34:35]
    v_cndmask_b32_e64 v89, v89, v11, s[34:35]
    v_cndmask_b32_e64 v90, v90, v11, s[34:35]
    v_cndmask_b32_e64 v91, v91, v11, s[34:35]
    s_lshr_b32 s30, s22, 1
    s_lshl_b32 s31, s21, 1
    s_add_u32 s30, s30, s31
    s_lshl_b32 s30, s30, 6
    s_lshl_b32 s31, s20, 1
    s_add_u32 s30, s30, s31
    s_and_b32 s31, s22, 1
    s_add_u32 s30, s30, s31
    s_lshl_b32 s30, s30, 11
    v_lshlrev_b32 v10, 4, v2
    s_add_u32 s31, s30, 0x0
    buffer_store_dwordx4 v[68:71], v10, s[64:67], s31 offen sc1
    buffer_store_dwordx4 v[72:75], v10, s[64:67], s31 offen offset:1024 sc1
    s_add_u32 s31, s30, 0x200000
    buffer_store_dwordx4 v[76:79], v10, s[64:67], s31 offen sc1
    buffer_store_dwordx4 v[80:83], v10, s[64:67], s31 offen offset:1024 sc1
    s_add_u32 s31, s30, 0x400000
    buffer_store_dwordx4 v[84:87], v10, s[64:67], s31 offen sc1
    buffer_store_dwordx4 v[88:91], v10, s[64:67], s31 offen offset:1024 sc1
    s_waitcnt vmcnt(0)
K1_END:
    s_endpgm
.globl k2_attn_kernel
.p2align 8
.type k2_attn_kernel,@function
k2_attn_kernel:
    s_cmp_ge_u32 s2, 256
    s_cbranch_scc1 K2_END
    s_cmp_ge_u32 s2, 8
    s_cbranch_scc1 K2_NOPF
    s_getpc_b64 s[92:93]
K2_PC:
    s_add_u32 s92, s92, k3_wo_kernel-K2_PC
    s_addc_u32 s93, s93, 0
    s_mov_b32 s94, k4_ffn1_kernel-k3_wo_kernel
    s_mov_b32 s95, 0x00020000
    v_lshlrev_b32 v247, 7, v0
    buffer_load_dword v247, v247, s[92:95], 0 offen
K2_NOPF:
    s_load_dwordx2 s[8:9], s[0:1], 72
    s_load_dwordx2 s[64:65], s[0:1], 16
    s_load_dwordx4 s[68:71], s[0:1], 32
    s_load_dwordx2 s[66:67], s[0:1], 48
    s_and_b32 s20, s2, 15
    s_lshr_b32 s21, s2, 4
    v_lshrrev_b32 v1, 6, v0
    v_and_b32 v2, 63, v0
    s_nop 0
    v_readfirstlane_b32 s22, v1
    v_lshlrev_b32 v3, 4, v2
    s_waitcnt lgkmcnt(0)
    s_mov_b32 s12, s8
    s_mov_b32 s13, s9
    s_mov_b32 s14, 0x600000
    s_mov_b32 s15, 0x00020000
    s_add_u32 s16, s8, 0x600000
    s_addc_u32 s17, s9, 0
    s_mov_b32 s18, 0x200000
    s_mov_b32 s19, 0x00020000
    s_mov_b32 s48, s64
    s_mov_b32 s49, s65
    s_mov_b32 s50, 0x62000
    s_mov_b32 s51, 0x00020000
    s_mov_b32 s52, s68
    s_mov_b32 s53, s69
    s_mov_b32 s54, 0x188000
    s_mov_b32 s55, 0x00020000
    s_mov_b32 s56, s70
    s_mov_b32 s57, s71
    s_mov_b32 s58, 0x188000
    s_mov_b32 s59, 0x00020000
    s_mov_b32 s60, s66
    s_mov_b32 s61, s67
    s_mov_b32 s62, 0x188000
    s_mov_b32 s63, 0x00020000
    s_lshl_b32 s44, s2, 3
    s_add_u32 s44, s44, s22
    s_lshl_b32 s44, s44, 10
    v_add_u32 v240, s44, v3
    v_subrev_u32 v241, 1605632, v240
    s_lshl_b32 s27, s20, 6
    s_lshl_b32 s28, s22, 3
    s_add_u32 s27, s27, s28
    s_lshl_b32 s27, s27, 11
    s_add_u32 s27, s27, 0x200000
    s_add_u32 s29, s27, 0x200000
    s_lshl_b32 s25, s20, 6
    s_lshl_b32 s26, s21, 2
    s_add_u32 s25, s25, s26
    s_lshl_b32 s25, s25, 11
    buffer_load_dwordx4 v[4:7], v3, s[12:15], s25 offen offset:0
    buffer_load_dwordx4 v[8:11], v3, s[12:15], s25 offen offset:1024
    buffer_load_dwordx4 v[12:15], v3, s[12:15], s25 offen offset:2048
    buffer_load_dwordx4 v[16:19], v3, s[12:15], s25 offen offset:3072
    s_add_u32 s25, s25, 4096
    buffer_load_dwordx4 v[20:23], v3, s[12:15], s25 offen offset:0
    buffer_load_dwordx4 v[24:27], v3, s[12:15], s25 offen offset:1024
    buffer_load_dwordx4 v[28:31], v3, s[12:15], s25 offen offset:2048
    buffer_load_dwordx4 v[32:35], v3, s[12:15], s25 offen offset:3072
    buffer_load_dwordx4 v[164:167], v3, s[12:15], s27 offen
    buffer_load_dwordx4 v[168:171], v3, s[12:15], s27 offen offset:1024
    buffer_load_dwordx4 v[172:175], v3, s[12:15], s29 offen
    buffer_load_dwordx4 v[176:179], v3, s[12:15], s29 offen offset:1024
    s_add_u32 s27, s27, 2048
    s_add_u32 s29, s29, 2048
    buffer_load_dwordx4 v[180:183], v3, s[12:15], s27 offen
    buffer_load_dwordx4 v[184:187], v3, s[12:15], s27 offen offset:1024
    buffer_load_dwordx4 v[188:191], v3, s[12:15], s29 offen
    buffer_load_dwordx4 v[192:195], v3, s[12:15], s29 offen offset:1024
    s_add_u32 s27, s27, 2048
    s_add_u32 s29, s29, 2048
    v_mov_b32 v36, 0
    v_mov_b32 v37, 0
    v_mov_b32 v38, 0
    v_mov_b32 v39, 0
    v_mov_b32 v40, 0
    v_mov_b32 v41, 0
    v_mov_b32 v42, 0
    v_mov_b32 v43, 0
    v_mov_b32 v44, 0
    v_mov_b32 v45, 0
    v_mov_b32 v46, 0
    v_mov_b32 v47, 0
    v_mov_b32 v48, 0
    v_mov_b32 v49, 0
    v_mov_b32 v50, 0
    v_mov_b32 v51, 0
    v_mov_b32 v52, 0
    v_mov_b32 v53, 0
    v_mov_b32 v54, 0
    v_mov_b32 v55, 0
    v_mov_b32 v56, 0
    v_mov_b32 v57, 0
    v_mov_b32 v58, 0
    v_mov_b32 v59, 0
    v_mov_b32 v60, 0
    v_mov_b32 v61, 0
    v_mov_b32 v62, 0
    v_mov_b32 v63, 0
    v_mov_b32 v64, 0
    v_mov_b32 v65, 0
    v_mov_b32 v66, 0
    v_mov_b32 v67, 0
    v_mov_b32 v68, 0
    v_mov_b32 v69, 0
    v_mov_b32 v70, 0
    v_mov_b32 v71, 0
    v_mov_b32 v72, 0
    v_mov_b32 v73, 0
    v_mov_b32 v74, 0
    v_mov_b32 v75, 0
    v_mov_b32 v76, 0
    v_mov_b32 v77, 0
    v_mov_b32 v78, 0
    v_mov_b32 v79, 0
    v_mov_b32 v80, 0
    v_mov_b32 v81, 0
    v_mov_b32 v82, 0
    v_mov_b32 v83, 0
    v_mov_b32 v84, 0
    v_mov_b32 v85, 0
    v_mov_b32 v86, 0
    v_mov_b32 v87, 0
    v_mov_b32 v88, 0
    v_mov_b32 v89, 0
    v_mov_b32 v90, 0
    v_mov_b32 v91, 0
    v_mov_b32 v92, 0
    v_mov_b32 v93, 0
    v_mov_b32 v94, 0
    v_mov_b32 v95, 0
    v_mov_b32 v96, 0
    v_mov_b32 v97, 0
    v_mov_b32 v98, 0
    v_mov_b32 v99, 0
    v_mov_b32 v212, 0
    v_mov_b32 v213, 0
    v_mov_b32 v214, 0
    v_mov_b32 v215, 0
    s_mov_b32 s32, 0
    s_mov_b32 s33, -1
    s_mov_b32 s36, 0x41000000
    s_mov_b32 s37, 0x40004000
    s_waitcnt vmcnt(4)
    v_mfma_f32_32x32x16_bf16 v[100:115], v[164:167], v[4:7], 0
    v_mfma_f32_32x32x16_bf16 v[100:115], v[168:171], v[8:11], v[100:115]
    s_setprio 3
    v_mfma_f32_32x32x16_bf16 v[116:131], v[164:167], v[12:15], 0
    v_mfma_f32_32x32x16_bf16 v[116:131], v[168:171], v[16:19], v[116:131]
    s_nop 15
    s_nop 3
    v_exp_f32 v132, v100
    v_exp_f32 v133, v101
    v_exp_f32 v134, v102
    v_exp_f32 v135, v103
    v_exp_f32 v136, v104
    v_exp_f32 v137, v105
    v_exp_f32 v138, v106
    v_exp_f32 v139, v107
    v_exp_f32 v140, v108
    v_exp_f32 v141, v109
    v_exp_f32 v142, v110
    v_exp_f32 v143, v111
    v_exp_f32 v144, v112
    v_exp_f32 v145, v113
    v_exp_f32 v146, v114
    v_exp_f32 v147, v115
    v_cvt_pk_bf16_f32 v148, v132, v133
    v_cvt_pk_bf16_f32 v149, v134, v135
    v_cvt_pk_bf16_f32 v150, v136, v137
    v_cvt_pk_bf16_f32 v151, v138, v139
    v_cvt_pk_bf16_f32 v152, v140, v141
    v_cvt_pk_bf16_f32 v153, v142, v143
    v_cvt_pk_bf16_f32 v154, v144, v145
    v_cvt_pk_bf16_f32 v155, v146, v147
    v_mfma_f32_32x32x16_bf16 v[100:115], v[164:167], v[20:23], 0
    v_exp_f32 v132, v116
    v_exp_f32 v133, v117
    v_exp_f32 v134, v118
    v_exp_f32 v135, v119
    v_mfma_f32_32x32x16_bf16 v[100:115], v[168:171], v[24:27], v[100:115]
    v_exp_f32 v136, v120
    v_exp_f32 v137, v121
    v_exp_f32 v138, v122
    v_exp_f32 v139, v123
    v_mfma_f32_32x32x16_bf16 v[36:51], v[172:175], v[148:151], v[36:51]
    v_exp_f32 v140, v124
    v_exp_f32 v141, v125
    v_exp_f32 v142, v126
    v_exp_f32 v143, v127
    v_mfma_f32_32x32x16_bf16 v[36:51], v[176:179], v[152:155], v[36:51]
    v_exp_f32 v144, v128
    v_exp_f32 v145, v129
    v_exp_f32 v146, v130
    v_exp_f32 v147, v131
    v_cvt_pk_bf16_f32 v156, v132, v133
    v_cvt_pk_bf16_f32 v157, v134, v135
    v_cvt_pk_bf16_f32 v158, v136, v137
    v_cvt_pk_bf16_f32 v159, v138, v139
    v_cvt_pk_bf16_f32 v160, v140, v141
    v_cvt_pk_bf16_f32 v161, v142, v143
    v_cvt_pk_bf16_f32 v162, v144, v145
    v_cvt_pk_bf16_f32 v163, v146, v147
    buffer_load_dwordx4 v[196:199], v3, s[12:15], s27 offen
    buffer_load_dwordx4 v[200:203], v3, s[12:15], s27 offen offset:1024
    buffer_load_dwordx4 v[204:207], v3, s[12:15], s29 offen
    buffer_load_dwordx4 v[208:211], v3, s[12:15], s29 offen offset:1024
    s_add_u32 s27, s27, 2048
    s_add_u32 s29, s29, 2048
    v_mfma_f32_32x32x16_bf16 v[116:131], v[164:167], v[28:31], 0
    v_exp_f32 v132, v100
    v_exp_f32 v133, v101
    v_exp_f32 v134, v102
    v_exp_f32 v135, v103
    v_mfma_f32_32x32x16_bf16 v[116:131], v[168:171], v[32:35], v[116:131]
    v_exp_f32 v136, v104
    v_exp_f32 v137, v105
    v_exp_f32 v138, v106
    v_exp_f32 v139, v107
    v_mfma_f32_32x32x16_bf16 v[52:67], v[172:175], v[156:159], v[52:67]
    v_exp_f32 v140, v108
    v_exp_f32 v141, v109
    v_exp_f32 v142, v110
    v_exp_f32 v143, v111
    v_mfma_f32_32x32x16_bf16 v[52:67], v[176:179], v[160:163], v[52:67]
    v_exp_f32 v144, v112
    v_exp_f32 v145, v113
    v_exp_f32 v146, v114
    v_exp_f32 v147, v115
    v_cvt_pk_bf16_f32 v148, v132, v133
    v_cvt_pk_bf16_f32 v149, v134, v135
    v_cvt_pk_bf16_f32 v150, v136, v137
    v_cvt_pk_bf16_f32 v151, v138, v139
    v_cvt_pk_bf16_f32 v152, v140, v141
    v_cvt_pk_bf16_f32 v153, v142, v143
    v_cvt_pk_bf16_f32 v154, v144, v145
    v_cvt_pk_bf16_f32 v155, v146, v147
    s_waitcnt vmcnt(4)
    v_mfma_f32_32x32x16_bf16 v[100:115], v[180:183], v[4:7], 0
    v_exp_f32 v132, v116
    v_exp_f32 v133, v117
    v_exp_f32 v134, v118
    v_exp_f32 v135, v119
    v_mfma_f32_32x32x16_bf16 v[100:115], v[184:187], v[8:11], v[100:115]
    v_exp_f32 v136, v120
    v_exp_f32 v137, v121
    v_exp_f32 v138, v122
    v_exp_f32 v139, v123
    v_mfma_f32_32x32x16_bf16 v[68:83], v[172:175], v[148:151], v[68:83]
    v_exp_f32 v140, v124
    v_exp_f32 v141, v125
    v_exp_f32 v142, v126
    v_exp_f32 v143, v127
    v_mfma_f32_32x32x16_bf16 v[68:83], v[176:179], v[152:155], v[68:83]
    v_exp_f32 v144, v128
    v_exp_f32 v145, v129
    v_exp_f32 v146, v130
    v_exp_f32 v147, v131
    v_cvt_pk_bf16_f32 v156, v132, v133
    v_cvt_pk_bf16_f32 v157, v134, v135
    v_cvt_pk_bf16_f32 v158, v136, v137
    v_cvt_pk_bf16_f32 v159, v138, v139
    v_cvt_pk_bf16_f32 v160, v140, v141
    v_cvt_pk_bf16_f32 v161, v142, v143
    v_cvt_pk_bf16_f32 v162, v144, v145
    v_cvt_pk_bf16_f32 v163, v146, v147
    v_mfma_f32_32x32x16_bf16 v[116:131], v[180:183], v[12:15], 0
    v_exp_f32 v132, v100
    v_exp_f32 v133, v101
    v_exp_f32 v134, v102
    v_exp_f32 v135, v103
    v_mfma_f32_32x32x16_bf16 v[116:131], v[184:187], v[16:19], v[116:131]
    v_exp_f32 v136, v104
    v_exp_f32 v137, v105
    v_exp_f32 v138, v106
    v_exp_f32 v139, v107
    v_mfma_f32_32x32x16_bf16 v[84:99], v[172:175], v[156:159], v[84:99]
    v_exp_f32 v140, v108
    v_exp_f32 v141, v109
    v_exp_f32 v142, v110
    v_exp_f32 v143, v111
    v_mfma_f32_32x32x16_bf16 v[84:99], v[176:179], v[160:163], v[84:99]
    v_exp_f32 v144, v112
    v_exp_f32 v145, v113
    v_exp_f32 v146, v114
    v_exp_f32 v147, v115
    v_cvt_pk_bf16_f32 v148, v132, v133
    v_cvt_pk_bf16_f32 v149, v134, v135
    v_cvt_pk_bf16_f32 v150, v136, v137
    v_cvt_pk_bf16_f32 v151, v138, v139
    v_cvt_pk_bf16_f32 v152, v140, v141
    v_cvt_pk_bf16_f32 v153, v142, v143
    v_cvt_pk_bf16_f32 v154, v144, v145
    v_cvt_pk_bf16_f32 v155, v146, v147
    v_mfma_f32_32x32x16_bf16 v[100:115], v[180:183], v[20:23], 0
    v_exp_f32 v132, v116
    v_exp_f32 v133, v117
    v_exp_f32 v134, v118
    v_exp_f32 v135, v119
    v_mfma_f32_32x32x16_bf16 v[100:115], v[184:187], v[24:27], v[100:115]
    v_exp_f32 v136, v120
    v_exp_f32 v137, v121
    v_exp_f32 v138, v122
    v_exp_f32 v139, v123
    v_mfma_f32_32x32x16_bf16 v[36:51], v[188:191], v[148:151], v[36:51]
    v_exp_f32 v140, v124
    v_exp_f32 v141, v125
    v_exp_f32 v142, v126
    v_exp_f32 v143, v127
    v_mfma_f32_32x32x16_bf16 v[36:51], v[192:195], v[152:155], v[36:51]
    v_exp_f32 v144, v128
    v_exp_f32 v145, v129
    v_exp_f32 v146, v130
    v_exp_f32 v147, v131
    v_cvt_pk_bf16_f32 v156, v132, v133
    v_cvt_pk_bf16_f32 v157, v134, v135
    v_cvt_pk_bf16_f32 v158, v136, v137
    v_cvt_pk_bf16_f32 v159, v138, v139
    v_cvt_pk_bf16_f32 v160, v140, v141
    v_cvt_pk_bf16_f32 v161, v142, v143
    v_cvt_pk_bf16_f32 v162, v144, v145
    v_cvt_pk_bf16_f32 v163, v146, v147
    buffer_load_dwordx4 v[164:167], v3, s[12:15], s27 offen
    buffer_load_dwordx4 v[168:171], v3, s[12:15], s27 offen offset:1024
    buffer_load_dwordx4 v[172:175], v3, s[12:15], s29 offen
    buffer_load_dwordx4 v[176:179], v3, s[12:15], s29 offen offset:1024
    s_add_u32 s27, s27, 2048
    s_add_u32 s29, s29, 2048
    v_mfma_f32_32x32x16_bf16 v[116:131], v[180:183], v[28:31], 0
    v_exp_f32 v132, v100
    v_exp_f32 v133, v101
    v_exp_f32 v134, v102
    v_exp_f32 v135, v103
    v_mfma_f32_32x32x16_bf16 v[116:131], v[184:187], v[32:35], v[116:131]
    v_exp_f32 v136, v104
    v_exp_f32 v137, v105
    v_exp_f32 v138, v106
    v_exp_f32 v139, v107
    v_mfma_f32_32x32x16_bf16 v[52:67], v[188:191], v[156:159], v[52:67]
    v_exp_f32 v140, v108
    v_exp_f32 v141, v109
    v_exp_f32 v142, v110
    v_exp_f32 v143, v111
    v_mfma_f32_32x32x16_bf16 v[52:67], v[192:195], v[160:163], v[52:67]
    v_exp_f32 v144, v112
    v_exp_f32 v145, v113
    v_exp_f32 v146, v114
    v_exp_f32 v147, v115
    v_cvt_pk_bf16_f32 v148, v132, v133
    v_cvt_pk_bf16_f32 v149, v134, v135
    v_cvt_pk_bf16_f32 v150, v136, v137
    v_cvt_pk_bf16_f32 v151, v138, v139
    v_cvt_pk_bf16_f32 v152, v140, v141
    v_cvt_pk_bf16_f32 v153, v142, v143
    v_cvt_pk_bf16_f32 v154, v144, v145
    v_cvt_pk_bf16_f32 v155, v146, v147
    s_waitcnt vmcnt(4)
    v_mfma_f32_32x32x16_bf16 v[100:115], v[196:199], v[4:7], 0
    v_exp_f32 v132, v116
    v_exp_f32 v133, v117
    v_exp_f32 v134, v118
    v_exp_f32 v135, v119
    v_mfma_f32_32x32x16_bf16 v[100:115], v[200:203], v[8:11], v[100:115]
    v_exp_f32 v136, v120
    v_exp_f32 v137, v121
    v_exp_f32 v138, v122
    v_exp_f32 v139, v123
    v_mfma_f32_32x32x16_bf16 v[68:83], v[188:191], v[148:151], v[68:83]
    v_exp_f32 v140, v124
    v_exp_f32 v141, v125
    v_exp_f32 v142, v126
    v_exp_f32 v143, v127
    v_mfma_f32_32x32x16_bf16 v[68:83], v[192:195], v[152:155], v[68:83]
    v_exp_f32 v144, v128
    v_exp_f32 v145, v129
    v_exp_f32 v146, v130
    v_exp_f32 v147, v131
    v_cvt_pk_bf16_f32 v156, v132, v133
    v_cvt_pk_bf16_f32 v157, v134, v135
    v_cvt_pk_bf16_f32 v158, v136, v137
    v_cvt_pk_bf16_f32 v159, v138, v139
    v_cvt_pk_bf16_f32 v160, v140, v141
    v_cvt_pk_bf16_f32 v161, v142, v143
    v_cvt_pk_bf16_f32 v162, v144, v145
    v_cvt_pk_bf16_f32 v163, v146, v147
    s_setprio 2
    v_mfma_f32_32x32x16_bf16 v[116:131], v[196:199], v[12:15], 0
    v_exp_f32 v132, v100
    v_exp_f32 v133, v101
    v_exp_f32 v134, v102
    v_exp_f32 v135, v103
    v_mfma_f32_32x32x16_bf16 v[116:131], v[200:203], v[16:19], v[116:131]
    v_exp_f32 v136, v104
    v_exp_f32 v137, v105
    v_exp_f32 v138, v106
    v_exp_f32 v139, v107
    v_mfma_f32_32x32x16_bf16 v[84:99], v[188:191], v[156:159], v[84:99]
    v_exp_f32 v140, v108
    v_exp_f32 v141, v109
    v_exp_f32 v142, v110
    v_exp_f32 v143, v111
    v_mfma_f32_32x32x16_bf16 v[84:99], v[192:195], v[160:163], v[84:99]
    v_exp_f32 v144, v112
    v_exp_f32 v145, v113
    v_exp_f32 v146, v114
    v_exp_f32 v147, v115
    v_cvt_pk_bf16_f32 v148, v132, v133
    v_cvt_pk_bf16_f32 v149, v134, v135
    v_cvt_pk_bf16_f32 v150, v136, v137
    v_cvt_pk_bf16_f32 v151, v138, v139
    v_cvt_pk_bf16_f32 v152, v140, v141
    v_cvt_pk_bf16_f32 v153, v142, v143
    v_cvt_pk_bf16_f32 v154, v144, v145
    v_cvt_pk_bf16_f32 v155, v146, v147
    v_mfma_f32_32x32x16_bf16 v[100:115], v[196:199], v[20:23], 0
    v_exp_f32 v132, v116
    v_exp_f32 v133, v117
    v_exp_f32 v134, v118
    v_exp_f32 v135, v119
    v_mfma_f32_32x32x16_bf16 v[100:115], v[200:203], v[24:27], v[100:115]
    v_exp_f32 v136, v120
    v_exp_f32 v137, v121
    v_exp_f32 v138, v122
    v_exp_f32 v139, v123
    v_mfma_f32_32x32x16_bf16 v[36:51], v[204:207], v[148:151], v[36:51]
    v_exp_f32 v140, v124
    v_exp_f32 v141, v125
    v_exp_f32 v142, v126
    v_exp_f32 v143, v127
    v_mfma_f32_32x32x16_bf16 v[36:51], v[208:211], v[152:155], v[36:51]
    v_exp_f32 v144, v128
    v_exp_f32 v145, v129
    v_exp_f32 v146, v130
    v_exp_f32 v147, v131
    v_cvt_pk_bf16_f32 v156, v132, v133
    v_cvt_pk_bf16_f32 v157, v134, v135
    v_cvt_pk_bf16_f32 v158, v136, v137
    v_cvt_pk_bf16_f32 v159, v138, v139
    v_cvt_pk_bf16_f32 v160, v140, v141
    v_cvt_pk_bf16_f32 v161, v142, v143
    v_cvt_pk_bf16_f32 v162, v144, v145
    v_cvt_pk_bf16_f32 v163, v146, v147
    buffer_load_dwordx4 v[180:183], v3, s[12:15], s27 offen
    buffer_load_dwordx4 v[184:187], v3, s[12:15], s27 offen offset:1024
    buffer_load_dwordx4 v[188:191], v3, s[12:15], s29 offen
    buffer_load_dwordx4 v[192:195], v3, s[12:15], s29 offen offset:1024
    s_add_u32 s27, s27, 2048
    s_add_u32 s29, s29, 2048
    v_mfma_f32_32x32x16_bf16 v[116:131], v[196:199], v[28:31], 0
    v_exp_f32 v132, v100
    v_exp_f32 v133, v101
    v_exp_f32 v134, v102
    v_exp_f32 v135, v103
    v_mfma_f32_32x32x16_bf16 v[116:131], v[200:203], v[32:35], v[116:131]
    v_exp_f32 v136, v104
    v_exp_f32 v137, v105
    v_exp_f32 v138, v106
    v_exp_f32 v139, v107
    v_mfma_f32_32x32x16_bf16 v[52:67], v[204:207], v[156:159], v[52:67]
    v_exp_f32 v140, v108
    v_exp_f32 v141, v109
    v_exp_f32 v142, v110
    v_exp_f32 v143, v111
    v_mfma_f32_32x32x16_bf16 v[52:67], v[208:211], v[160:163], v[52:67]
    v_exp_f32 v144, v112
    v_exp_f32 v145, v113
    v_exp_f32 v146, v114
    v_exp_f32 v147, v115
    v_cvt_pk_bf16_f32 v148, v132, v133
    v_cvt_pk_bf16_f32 v149, v134, v135
    v_cvt_pk_bf16_f32 v150, v136, v137
    v_cvt_pk_bf16_f32 v151, v138, v139
    v_cvt_pk_bf16_f32 v152, v140, v141
    v_cvt_pk_bf16_f32 v153, v142, v143
    v_cvt_pk_bf16_f32 v154, v144, v145
    v_cvt_pk_bf16_f32 v155, v146, v147
    s_waitcnt vmcnt(4)
    v_mfma_f32_32x32x16_bf16 v[100:115], v[164:167], v[4:7], 0
    v_exp_f32 v132, v116
    v_exp_f32 v133, v117
    v_exp_f32 v134, v118
    v_exp_f32 v135, v119
    v_mfma_f32_32x32x16_bf16 v[100:115], v[168:171], v[8:11], v[100:115]
    v_exp_f32 v136, v120
    v_exp_f32 v137, v121
    v_exp_f32 v138, v122
    v_exp_f32 v139, v123
    v_mfma_f32_32x32x16_bf16 v[68:83], v[204:207], v[148:151], v[68:83]
    v_exp_f32 v140, v124
    v_exp_f32 v141, v125
    v_exp_f32 v142, v126
    v_exp_f32 v143, v127
    v_mfma_f32_32x32x16_bf16 v[68:83], v[208:211], v[152:155], v[68:83]
    v_exp_f32 v144, v128
    v_exp_f32 v145, v129
    v_exp_f32 v146, v130
    v_exp_f32 v147, v131
    v_cvt_pk_bf16_f32 v156, v132, v133
    v_cvt_pk_bf16_f32 v157, v134, v135
    v_cvt_pk_bf16_f32 v158, v136, v137
    v_cvt_pk_bf16_f32 v159, v138, v139
    v_cvt_pk_bf16_f32 v160, v140, v141
    v_cvt_pk_bf16_f32 v161, v142, v143
    v_cvt_pk_bf16_f32 v162, v144, v145
    v_cvt_pk_bf16_f32 v163, v146, v147
    v_mfma_f32_32x32x16_bf16 v[116:131], v[164:167], v[12:15], 0
    v_exp_f32 v132, v100
    v_exp_f32 v133, v101
    v_exp_f32 v134, v102
    v_exp_f32 v135, v103
    v_mfma_f32_32x32x16_bf16 v[116:131], v[168:171], v[16:19], v[116:131]
    v_exp_f32 v136, v104
    v_exp_f32 v137, v105
    v_exp_f32 v138, v106
    v_exp_f32 v139, v107
    v_mfma_f32_32x32x16_bf16 v[84:99], v[204:207], v[156:159], v[84:99]
    v_exp_f32 v140, v108
    v_exp_f32 v141, v109
    v_exp_f32 v142, v110
    v_exp_f32 v143, v111
    v_mfma_f32_32x32x16_bf16 v[84:99], v[208:211], v[160:163], v[84:99]
    v_exp_f32 v144, v112
    v_exp_f32 v145, v113
    v_exp_f32 v146, v114
    v_exp_f32 v147, v115
    v_cvt_pk_bf16_f32 v148, v132, v133
    v_cvt_pk_bf16_f32 v149, v134, v135
    v_cvt_pk_bf16_f32 v150, v136, v137
    v_cvt_pk_bf16_f32 v151, v138, v139
    v_cvt_pk_bf16_f32 v152, v140, v141
    v_cvt_pk_bf16_f32 v153, v142, v143
    v_cvt_pk_bf16_f32 v154, v144, v145
    v_cvt_pk_bf16_f32 v155, v146, v147
    v_mfma_f32_32x32x16_bf16 v[100:115], v[164:167], v[20:23], 0
    v_exp_f32 v132, v116
    v_exp_f32 v133, v117
    v_exp_f32 v134, v118
    v_exp_f32 v135, v119
    v_mfma_f32_32x32x16_bf16 v[100:115], v[168:171], v[24:27], v[100:115]
    v_exp_f32 v136, v120
    v_exp_f32 v137, v121
    v_exp_f32 v138, v122
    v_exp_f32 v139, v123
    v_mfma_f32_32x32x16_bf16 v[36:51], v[172:175], v[148:151], v[36:51]
    v_exp_f32 v140, v124
    v_exp_f32 v141, v125
    v_exp_f32 v142, v126
    v_exp_f32 v143, v127
    v_mfma_f32_32x32x16_bf16 v[36:51], v[176:179], v[152:155], v[36:51]
    v_exp_f32 v144, v128
    v_exp_f32 v145, v129
    v_exp_f32 v146, v130
    v_exp_f32 v147, v131
    v_cvt_pk_bf16_f32 v156, v132, v133
    v_cvt_pk_bf16_f32 v157, v134, v135
    v_cvt_pk_bf16_f32 v158, v136, v137
    v_cvt_pk_bf16_f32 v159, v138, v139
    v_cvt_pk_bf16_f32 v160, v140, v141
    v_cvt_pk_bf16_f32 v161, v142, v143
    v_cvt_pk_bf16_f32 v162, v144, v145
    v_cvt_pk_bf16_f32 v163, v146, v147
    buffer_load_dwordx4 v[196:199], v3, s[12:15], s27 offen
    buffer_load_dwordx4 v[200:203], v3, s[12:15], s27 offen offset:1024
    buffer_load_dwordx4 v[204:207], v3, s[12:15], s29 offen
    buffer_load_dwordx4 v[208:211], v3, s[12:15], s29 offen offset:1024
    s_add_u32 s27, s27, 2048
    s_add_u32 s29, s29, 2048
    v_mfma_f32_32x32x16_bf16 v[116:131], v[164:167], v[28:31], 0
    v_exp_f32 v132, v100
    v_exp_f32 v133, v101
    v_exp_f32 v134, v102
    v_exp_f32 v135, v103
    v_mfma_f32_32x32x16_bf16 v[116:131], v[168:171], v[32:35], v[116:131]
    v_exp_f32 v136, v104
    v_exp_f32 v137, v105
    v_exp_f32 v138, v106
    v_exp_f32 v139, v107
    v_mfma_f32_32x32x16_bf16 v[52:67], v[172:175], v[156:159], v[52:67]
    v_exp_f32 v140, v108
    v_exp_f32 v141, v109
    v_exp_f32 v142, v110
    v_exp_f32 v143, v111
    v_mfma_f32_32x32x16_bf16 v[52:67], v[176:179], v[160:163], v[52:67]
    v_exp_f32 v144, v112
    v_exp_f32 v145, v113
    v_exp_f32 v146, v114
    v_exp_f32 v147, v115
    v_cvt_pk_bf16_f32 v148, v132, v133
    v_cvt_pk_bf16_f32 v149, v134, v135
    v_cvt_pk_bf16_f32 v150, v136, v137
    v_cvt_pk_bf16_f32 v151, v138, v139
    v_cvt_pk_bf16_f32 v152, v140, v141
    v_cvt_pk_bf16_f32 v153, v142, v143
    v_cvt_pk_bf16_f32 v154, v144, v145
    v_cvt_pk_bf16_f32 v155, v146, v147
    s_waitcnt vmcnt(4)
    v_mfma_f32_32x32x16_bf16 v[100:115], v[180:183], v[4:7], 0
    v_exp_f32 v132, v116
    v_exp_f32 v133, v117
    v_exp_f32 v134, v118
    v_exp_f32 v135, v119
    v_mfma_f32_32x32x16_bf16 v[100:115], v[184:187], v[8:11], v[100:115]
    v_exp_f32 v136, v120
    v_exp_f32 v137, v121
    v_exp_f32 v138, v122
    v_exp_f32 v139, v123
    v_mfma_f32_32x32x16_bf16 v[68:83], v[172:175], v[148:151], v[68:83]
    v_exp_f32 v140, v124
    v_exp_f32 v141, v125
    v_exp_f32 v142, v126
    v_exp_f32 v143, v127
    v_mfma_f32_32x32x16_bf16 v[68:83], v[176:179], v[152:155], v[68:83]
    v_exp_f32 v144, v128
    v_exp_f32 v145, v129
    v_exp_f32 v146, v130
    v_exp_f32 v147, v131
    v_cvt_pk_bf16_f32 v156, v132, v133
    v_cvt_pk_bf16_f32 v157, v134, v135
    v_cvt_pk_bf16_f32 v158, v136, v137
    v_cvt_pk_bf16_f32 v159, v138, v139
    v_cvt_pk_bf16_f32 v160, v140, v141
    v_cvt_pk_bf16_f32 v161, v142, v143
    v_cvt_pk_bf16_f32 v162, v144, v145
    v_cvt_pk_bf16_f32 v163, v146, v147
    s_setprio 1
    v_mfma_f32_32x32x16_bf16 v[116:131], v[180:183], v[12:15], 0
    v_exp_f32 v132, v100
    v_exp_f32 v133, v101
    v_exp_f32 v134, v102
    v_exp_f32 v135, v103
    v_mfma_f32_32x32x16_bf16 v[116:131], v[184:187], v[16:19], v[116:131]
    v_exp_f32 v136, v104
    v_exp_f32 v137, v105
    v_exp_f32 v138, v106
    v_exp_f32 v139, v107
    v_mfma_f32_32x32x16_bf16 v[84:99], v[172:175], v[156:159], v[84:99]
    v_exp_f32 v140, v108
    v_exp_f32 v141, v109
    v_exp_f32 v142, v110
    v_exp_f32 v143, v111
    v_mfma_f32_32x32x16_bf16 v[84:99], v[176:179], v[160:163], v[84:99]
    v_exp_f32 v144, v112
    v_exp_f32 v145, v113
    v_exp_f32 v146, v114
    v_exp_f32 v147, v115
    v_cvt_pk_bf16_f32 v148, v132, v133
    v_cvt_pk_bf16_f32 v149, v134, v135
    v_cvt_pk_bf16_f32 v150, v136, v137
    v_cvt_pk_bf16_f32 v151, v138, v139
    v_cvt_pk_bf16_f32 v152, v140, v141
    v_cvt_pk_bf16_f32 v153, v142, v143
    v_cvt_pk_bf16_f32 v154, v144, v145
    v_cvt_pk_bf16_f32 v155, v146, v147
    v_mfma_f32_32x32x16_bf16 v[100:115], v[180:183], v[20:23], 0
    v_exp_f32 v132, v116
    v_exp_f32 v133, v117
    v_exp_f32 v134, v118
    v_exp_f32 v135, v119
    v_mfma_f32_32x32x16_bf16 v[100:115], v[184:187], v[24:27], v[100:115]
    v_exp_f32 v136, v120
    v_exp_f32 v137, v121
    v_exp_f32 v138, v122
    v_exp_f32 v139, v123
    v_mfma_f32_32x32x16_bf16 v[36:51], v[188:191], v[148:151], v[36:51]
    v_exp_f32 v140, v124
    v_exp_f32 v141, v125
    v_exp_f32 v142, v126
    v_exp_f32 v143, v127
    v_mfma_f32_32x32x16_bf16 v[36:51], v[192:195], v[152:155], v[36:51]
    v_exp_f32 v144, v128
    v_exp_f32 v145, v129
    v_exp_f32 v146, v130
    v_exp_f32 v147, v131
    v_cvt_pk_bf16_f32 v156, v132, v133
    v_cvt_pk_bf16_f32 v157, v134, v135
    v_cvt_pk_bf16_f32 v158, v136, v137
    v_cvt_pk_bf16_f32 v159, v138, v139
    v_cvt_pk_bf16_f32 v160, v140, v141
    v_cvt_pk_bf16_f32 v161, v142, v143
    v_cvt_pk_bf16_f32 v162, v144, v145
    v_cvt_pk_bf16_f32 v163, v146, v147
    buffer_load_dwordx4 v[164:167], v3, s[12:15], s27 offen
    buffer_load_dwordx4 v[168:171], v3, s[12:15], s27 offen offset:1024
    buffer_load_dwordx4 v[172:175], v3, s[12:15], s29 offen
    buffer_load_dwordx4 v[176:179], v3, s[12:15], s29 offen offset:1024
    s_add_u32 s27, s27, 2048
    s_add_u32 s29, s29, 2048
    v_mfma_f32_32x32x16_bf16 v[116:131], v[180:183], v[28:31], 0
    v_exp_f32 v132, v100
    v_exp_f32 v133, v101
    v_exp_f32 v134, v102
    v_exp_f32 v135, v103
    v_mfma_f32_32x32x16_bf16 v[116:131], v[184:187], v[32:35], v[116:131]
    v_exp_f32 v136, v104
    v_exp_f32 v137, v105
    v_exp_f32 v138, v106
    v_exp_f32 v139, v107
    v_mfma_f32_32x32x16_bf16 v[52:67], v[188:191], v[156:159], v[52:67]
    v_exp_f32 v140, v108
    v_exp_f32 v141, v109
    v_exp_f32 v142, v110
    v_exp_f32 v143, v111
    v_mfma_f32_32x32x16_bf16 v[52:67], v[192:195], v[160:163], v[52:67]
    v_exp_f32 v144, v112
    v_exp_f32 v145, v113
    v_exp_f32 v146, v114
    v_exp_f32 v147, v115
    v_cvt_pk_bf16_f32 v148, v132, v133
    v_cvt_pk_bf16_f32 v149, v134, v135
    v_cvt_pk_bf16_f32 v150, v136, v137
    v_cvt_pk_bf16_f32 v151, v138, v139
    v_cvt_pk_bf16_f32 v152, v140, v141
    v_cvt_pk_bf16_f32 v153, v142, v143
    v_cvt_pk_bf16_f32 v154, v144, v145
    v_cvt_pk_bf16_f32 v155, v146, v147
    s_waitcnt vmcnt(4)
    v_mfma_f32_32x32x16_bf16 v[100:115], v[196:199], v[4:7], 0
    v_exp_f32 v132, v116
    v_exp_f32 v133, v117
    v_exp_f32 v134, v118
    v_exp_f32 v135, v119
    v_mfma_f32_32x32x16_bf16 v[100:115], v[200:203], v[8:11], v[100:115]
    v_exp_f32 v136, v120
    v_exp_f32 v137, v121
    v_exp_f32 v138, v122
    v_exp_f32 v139, v123
    v_mfma_f32_32x32x16_bf16 v[68:83], v[188:191], v[148:151], v[68:83]
    v_exp_f32 v140, v124
    v_exp_f32 v141, v125
    v_exp_f32 v142, v126
    v_exp_f32 v143, v127
    v_mfma_f32_32x32x16_bf16 v[68:83], v[192:195], v[152:155], v[68:83]
    v_exp_f32 v144, v128
    v_exp_f32 v145, v129
    v_exp_f32 v146, v130
    v_exp_f32 v147, v131
    v_cvt_pk_bf16_f32 v156, v132, v133
    v_cvt_pk_bf16_f32 v157, v134, v135
    v_cvt_pk_bf16_f32 v158, v136, v137
    v_cvt_pk_bf16_f32 v159, v138, v139
    v_cvt_pk_bf16_f32 v160, v140, v141
    v_cvt_pk_bf16_f32 v161, v142, v143
    v_cvt_pk_bf16_f32 v162, v144, v145
    v_cvt_pk_bf16_f32 v163, v146, v147
    v_mfma_f32_32x32x16_bf16 v[116:131], v[196:199], v[12:15], 0
    v_exp_f32 v132, v100
    v_exp_f32 v133, v101
    v_exp_f32 v134, v102
    v_exp_f32 v135, v103
    v_mfma_f32_32x32x16_bf16 v[116:131], v[200:203], v[16:19], v[116:131]
    v_exp_f32 v136, v104
    v_exp_f32 v137, v105
    v_exp_f32 v138, v106
    v_exp_f32 v139, v107
    v_mfma_f32_32x32x16_bf16 v[84:99], v[188:191], v[156:159], v[84:99]
    v_exp_f32 v140, v108
    v_exp_f32 v141, v109
    v_exp_f32 v142, v110
    v_exp_f32 v143, v111
    v_mfma_f32_32x32x16_bf16 v[84:99], v[192:195], v[160:163], v[84:99]
    v_exp_f32 v144, v112
    v_exp_f32 v145, v113
    v_exp_f32 v146, v114
    v_exp_f32 v147, v115
    v_cvt_pk_bf16_f32 v148, v132, v133
    v_cvt_pk_bf16_f32 v149, v134, v135
    v_cvt_pk_bf16_f32 v150, v136, v137
    v_cvt_pk_bf16_f32 v151, v138, v139
    v_cvt_pk_bf16_f32 v152, v140, v141
    v_cvt_pk_bf16_f32 v153, v142, v143
    v_cvt_pk_bf16_f32 v154, v144, v145
    v_cvt_pk_bf16_f32 v155, v146, v147
    v_mfma_f32_32x32x16_bf16 v[100:115], v[196:199], v[20:23], 0
    v_exp_f32 v132, v116
    v_exp_f32 v133, v117
    v_exp_f32 v134, v118
    v_exp_f32 v135, v119
    v_mfma_f32_32x32x16_bf16 v[100:115], v[200:203], v[24:27], v[100:115]
    v_exp_f32 v136, v120
    v_exp_f32 v137, v121
    v_exp_f32 v138, v122
    v_exp_f32 v139, v123
    v_mfma_f32_32x32x16_bf16 v[36:51], v[204:207], v[148:151], v[36:51]
    v_exp_f32 v140, v124
    v_exp_f32 v141, v125
    v_exp_f32 v142, v126
    v_exp_f32 v143, v127
    v_mfma_f32_32x32x16_bf16 v[36:51], v[208:211], v[152:155], v[36:51]
    v_exp_f32 v144, v128
    v_exp_f32 v145, v129
    v_exp_f32 v146, v130
    v_exp_f32 v147, v131
    v_cvt_pk_bf16_f32 v156, v132, v133
    v_cvt_pk_bf16_f32 v157, v134, v135
    v_cvt_pk_bf16_f32 v158, v136, v137
    v_cvt_pk_bf16_f32 v159, v138, v139
    v_cvt_pk_bf16_f32 v160, v140, v141
    v_cvt_pk_bf16_f32 v161, v142, v143
    v_cvt_pk_bf16_f32 v162, v144, v145
    v_cvt_pk_bf16_f32 v163, v146, v147
    buffer_load_dwordx4 v[180:183], v3, s[12:15], s27 offen
    buffer_load_dwordx4 v[184:187], v3, s[12:15], s27 offen offset:1024
    buffer_load_dwordx4 v[188:191], v3, s[12:15], s29 offen
    buffer_load_dwordx4 v[192:195], v3, s[12:15], s29 offen offset:1024
    s_add_u32 s27, s27, 2048
    s_add_u32 s29, s29, 2048
    buffer_load_dwordx4 v[224:227], v241, s[48:51], 0 offen
    buffer_load_dwordx4 v[228:231], v240, s[52:55], 0 offen
    buffer_load_dwordx4 v[232:235], v240, s[56:59], 0 offen
    buffer_load_dwordx4 v[236:239], v240, s[60:63], 0 offen
    v_mfma_f32_32x32x16_bf16 v[116:131], v[196:199], v[28:31], 0
    v_exp_f32 v132, v100
    v_exp_f32 v133, v101
    v_exp_f32 v134, v102
    v_exp_f32 v135, v103
    v_mfma_f32_32x32x16_bf16 v[116:131], v[200:203], v[32:35], v[116:131]
    v_exp_f32 v136, v104
    v_exp_f32 v137, v105
    v_exp_f32 v138, v106
    v_exp_f32 v139, v107
    v_mfma_f32_32x32x16_bf16 v[52:67], v[204:207], v[156:159], v[52:67]
    v_exp_f32 v140, v108
    v_exp_f32 v141, v109
    v_exp_f32 v142, v110
    v_exp_f32 v143, v111
    v_mfma_f32_32x32x16_bf16 v[52:67], v[208:211], v[160:163], v[52:67]
    v_exp_f32 v144, v112
    v_exp_f32 v145, v113
    v_exp_f32 v146, v114
    v_exp_f32 v147, v115
    v_cvt_pk_bf16_f32 v148, v132, v133
    v_cvt_pk_bf16_f32 v149, v134, v135
    v_cvt_pk_bf16_f32 v150, v136, v137
    v_cvt_pk_bf16_f32 v151, v138, v139
    v_cvt_pk_bf16_f32 v152, v140, v141
    v_cvt_pk_bf16_f32 v153, v142, v143
    v_cvt_pk_bf16_f32 v154, v144, v145
    v_cvt_pk_bf16_f32 v155, v146, v147
    s_waitcnt vmcnt(8)
    v_mfma_f32_32x32x16_bf16 v[100:115], v[164:167], v[4:7], 0
    v_exp_f32 v132, v116
    v_exp_f32 v133, v117
    v_exp_f32 v134, v118
    v_exp_f32 v135, v119
    v_mfma_f32_32x32x16_bf16 v[100:115], v[168:171], v[8:11], v[100:115]
    v_exp_f32 v136, v120
    v_exp_f32 v137, v121
    v_exp_f32 v138, v122
    v_exp_f32 v139, v123
    v_mfma_f32_32x32x16_bf16 v[68:83], v[204:207], v[148:151], v[68:83]
    v_exp_f32 v140, v124
    v_exp_f32 v141, v125
    v_exp_f32 v142, v126
    v_exp_f32 v143, v127
    v_mfma_f32_32x32x16_bf16 v[68:83], v[208:211], v[152:155], v[68:83]
    v_exp_f32 v144, v128
    v_exp_f32 v145, v129
    v_exp_f32 v146, v130
    v_exp_f32 v147, v131
    v_cvt_pk_bf16_f32 v156, v132, v133
    v_cvt_pk_bf16_f32 v157, v134, v135
    v_cvt_pk_bf16_f32 v158, v136, v137
    v_cvt_pk_bf16_f32 v159, v138, v139
    v_cvt_pk_bf16_f32 v160, v140, v141
    v_cvt_pk_bf16_f32 v161, v142, v143
    v_cvt_pk_bf16_f32 v162, v144, v145
    v_cvt_pk_bf16_f32 v163, v146, v147
    s_setprio 0
    v_mfma_f32_32x32x16_bf16 v[116:131], v[164:167], v[12:15], 0
    v_exp_f32 v132, v100
    v_exp_f32 v133, v101
    v_exp_f32 v134, v102
    v_exp_f32 v135, v103
    v_mfma_f32_32x32x16_bf16 v[116:131], v[168:171], v[16:19], v[116:131]
    v_exp_f32 v136, v104
    v_exp_f32 v137, v105
    v_exp_f32 v138, v106
    v_exp_f32 v139, v107
    v_mfma_f32_32x32x16_bf16 v[84:99], v[204:207], v[156:159], v[84:99]
    v_exp_f32 v140, v108
    v_exp_f32 v141, v109
    v_exp_f32 v142, v110
    v_exp_f32 v143, v111
    v_mfma_f32_32x32x16_bf16 v[84:99], v[208:211], v[160:163], v[84:99]
    v_exp_f32 v144, v112
    v_exp_f32 v145, v113
    v_exp_f32 v146, v114
    v_exp_f32 v147, v115
    v_cvt_pk_bf16_f32 v148, v132, v133
    v_cvt_pk_bf16_f32 v149, v134, v135
    v_cvt_pk_bf16_f32 v150, v136, v137
    v_cvt_pk_bf16_f32 v151, v138, v139
    v_cvt_pk_bf16_f32 v152, v140, v141
    v_cvt_pk_bf16_f32 v153, v142, v143
    v_cvt_pk_bf16_f32 v154, v144, v145
    v_cvt_pk_bf16_f32 v155, v146, v147
    v_mfma_f32_32x32x16_bf16 v[100:115], v[164:167], v[20:23], 0
    v_exp_f32 v132, v116
    v_exp_f32 v133, v117
    v_exp_f32 v134, v118
    v_exp_f32 v135, v119
    v_mfma_f32_32x32x16_bf16 v[100:115], v[168:171], v[24:27], v[100:115]
    v_exp_f32 v136, v120
    v_exp_f32 v137, v121
    v_exp_f32 v138, v122
    v_exp_f32 v139, v123
    v_mfma_f32_32x32x16_bf16 v[36:51], v[172:175], v[148:151], v[36:51]
    v_exp_f32 v140, v124
    v_exp_f32 v141, v125
    v_exp_f32 v142, v126
    v_exp_f32 v143, v127
    v_mfma_f32_32x32x16_bf16 v[36:51], v[176:179], v[152:155], v[36:51]
    v_exp_f32 v144, v128
    v_exp_f32 v145, v129
    v_exp_f32 v146, v130
    v_exp_f32 v147, v131
    v_cvt_pk_bf16_f32 v156, v132, v133
    v_cvt_pk_bf16_f32 v157, v134, v135
    v_cvt_pk_bf16_f32 v158, v136, v137
    v_cvt_pk_bf16_f32 v159, v138, v139
    v_cvt_pk_bf16_f32 v160, v140, v141
    v_cvt_pk_bf16_f32 v161, v142, v143
    v_cvt_pk_bf16_f32 v162, v144, v145
    v_cvt_pk_bf16_f32 v163, v146, v147
    v_mfma_f32_32x32x16_bf16 v[116:131], v[164:167], v[28:31], 0
    v_exp_f32 v132, v100
    v_exp_f32 v133, v101
    v_exp_f32 v134, v102
    v_exp_f32 v135, v103
    v_mfma_f32_32x32x16_bf16 v[116:131], v[168:171], v[32:35], v[116:131]
    v_exp_f32 v136, v104
    v_exp_f32 v137, v105
    v_exp_f32 v138, v106
    v_exp_f32 v139, v107
    v_mfma_f32_32x32x16_bf16 v[52:67], v[172:175], v[156:159], v[52:67]
    v_exp_f32 v140, v108
    v_exp_f32 v141, v109
    v_exp_f32 v142, v110
    v_exp_f32 v143, v111
    v_mfma_f32_32x32x16_bf16 v[52:67], v[176:179], v[160:163], v[52:67]
    v_exp_f32 v144, v112
    v_exp_f32 v145, v113
    v_exp_f32 v146, v114
    v_exp_f32 v147, v115
    v_cvt_pk_bf16_f32 v148, v132, v133
    v_cvt_pk_bf16_f32 v149, v134, v135
    v_cvt_pk_bf16_f32 v150, v136, v137
    v_cvt_pk_bf16_f32 v151, v138, v139
    v_cvt_pk_bf16_f32 v152, v140, v141
    v_cvt_pk_bf16_f32 v153, v142, v143
    v_cvt_pk_bf16_f32 v154, v144, v145
    v_cvt_pk_bf16_f32 v155, v146, v147
    s_waitcnt vmcnt(4)
    v_mfma_f32_32x32x16_bf16 v[100:115], v[180:183], v[4:7], 0
    v_exp_f32 v132, v116
    v_exp_f32 v133, v117
    v_exp_f32 v134, v118
    v_exp_f32 v135, v119
    v_mfma_f32_32x32x16_bf16 v[100:115], v[184:187], v[8:11], v[100:115]
    v_exp_f32 v136, v120
    v_exp_f32 v137, v121
    v_exp_f32 v138, v122
    v_exp_f32 v139, v123
    v_mfma_f32_32x32x16_bf16 v[68:83], v[172:175], v[148:151], v[68:83]
    v_exp_f32 v140, v124
    v_exp_f32 v141, v125
    v_exp_f32 v142, v126
    v_exp_f32 v143, v127
    v_mfma_f32_32x32x16_bf16 v[68:83], v[176:179], v[152:155], v[68:83]
    v_exp_f32 v144, v128
    v_exp_f32 v145, v129
    v_exp_f32 v146, v130
    v_exp_f32 v147, v131
    v_cvt_pk_bf16_f32 v156, v132, v133
    v_cvt_pk_bf16_f32 v157, v134, v135
    v_cvt_pk_bf16_f32 v158, v136, v137
    v_cvt_pk_bf16_f32 v159, v138, v139
    v_cvt_pk_bf16_f32 v160, v140, v141
    v_cvt_pk_bf16_f32 v161, v142, v143
    v_cvt_pk_bf16_f32 v162, v144, v145
    v_cvt_pk_bf16_f32 v163, v146, v147
    v_mfma_f32_32x32x16_bf16 v[116:131], v[180:183], v[12:15], 0
    v_exp_f32 v132, v100
    v_exp_f32 v133, v101
    v_exp_f32 v134, v102
    v_exp_f32 v135, v103
    v_mfma_f32_32x32x16_bf16 v[116:131], v[184:187], v[16:19], v[116:131]
    v_exp_f32 v136, v104
    v_exp_f32 v137, v105
    v_exp_f32 v138, v106
    v_exp_f32 v139, v107
    v_mfma_f32_32x32x16_bf16 v[84:99], v[172:175], v[156:159], v[84:99]
    v_exp_f32 v140, v108
    v_exp_f32 v141, v109
    v_exp_f32 v142, v110
    v_exp_f32 v143, v111
    v_mfma_f32_32x32x16_bf16 v[84:99], v[176:179], v[160:163], v[84:99]
    v_exp_f32 v144, v112
    v_exp_f32 v145, v113
    v_exp_f32 v146, v114
    v_exp_f32 v147, v115
    v_cvt_pk_bf16_f32 v148, v132, v133
    v_cvt_pk_bf16_f32 v149, v134, v135
    v_cvt_pk_bf16_f32 v150, v136, v137
    v_cvt_pk_bf16_f32 v151, v138, v139
    v_cvt_pk_bf16_f32 v152, v140, v141
    v_cvt_pk_bf16_f32 v153, v142, v143
    v_cvt_pk_bf16_f32 v154, v144, v145
    v_cvt_pk_bf16_f32 v155, v146, v147
    v_mfma_f32_32x32x16_bf16 v[100:115], v[180:183], v[20:23], 0
    v_exp_f32 v132, v116
    v_exp_f32 v133, v117
    v_exp_f32 v134, v118
    v_exp_f32 v135, v119
    v_mfma_f32_32x32x16_bf16 v[100:115], v[184:187], v[24:27], v[100:115]
    v_exp_f32 v136, v120
    v_exp_f32 v137, v121
    v_exp_f32 v138, v122
    v_exp_f32 v139, v123
    v_mfma_f32_32x32x16_bf16 v[36:51], v[188:191], v[148:151], v[36:51]
    v_exp_f32 v140, v124
    v_exp_f32 v141, v125
    v_exp_f32 v142, v126
    v_exp_f32 v143, v127
    v_mfma_f32_32x32x16_bf16 v[36:51], v[192:195], v[152:155], v[36:51]
    v_exp_f32 v144, v128
    v_exp_f32 v145, v129
    v_exp_f32 v146, v130
    v_exp_f32 v147, v131
    v_cvt_pk_bf16_f32 v156, v132, v133
    v_cvt_pk_bf16_f32 v157, v134, v135
    v_cvt_pk_bf16_f32 v158, v136, v137
    v_cvt_pk_bf16_f32 v159, v138, v139
    v_cvt_pk_bf16_f32 v160, v140, v141
    v_cvt_pk_bf16_f32 v161, v142, v143
    v_cvt_pk_bf16_f32 v162, v144, v145
    v_cvt_pk_bf16_f32 v163, v146, v147
    v_mfma_f32_32x32x16_bf16 v[116:131], v[180:183], v[28:31], 0
    v_exp_f32 v132, v100
    v_exp_f32 v133, v101
    v_exp_f32 v134, v102
    v_exp_f32 v135, v103
    v_mfma_f32_32x32x16_bf16 v[116:131], v[184:187], v[32:35], v[116:131]
    v_exp_f32 v136, v104
    v_exp_f32 v137, v105
    v_exp_f32 v138, v106
    v_exp_f32 v139, v107
    v_mfma_f32_32x32x16_bf16 v[52:67], v[188:191], v[156:159], v[52:67]
    v_exp_f32 v140, v108
    v_exp_f32 v141, v109
    v_exp_f32 v142, v110
    v_exp_f32 v143, v111
    v_mfma_f32_32x32x16_bf16 v[52:67], v[192:195], v[160:163], v[52:67]
    v_exp_f32 v144, v112
    v_exp_f32 v145, v113
    v_exp_f32 v146, v114
    v_exp_f32 v147, v115
    v_cvt_pk_bf16_f32 v148, v132, v133
    v_cvt_pk_bf16_f32 v149, v134, v135
    v_cvt_pk_bf16_f32 v150, v136, v137
    v_cvt_pk_bf16_f32 v151, v138, v139
    v_cvt_pk_bf16_f32 v152, v140, v141
    v_cvt_pk_bf16_f32 v153, v142, v143
    v_cvt_pk_bf16_f32 v154, v144, v145
    v_cvt_pk_bf16_f32 v155, v146, v147
    v_mfma_f32_32x32x16_bf16 v[68:83], v[188:191], v[148:151], v[68:83]
    v_exp_f32 v132, v116
    v_exp_f32 v133, v117
    v_exp_f32 v134, v118
    v_exp_f32 v135, v119
    v_mfma_f32_32x32x16_bf16 v[68:83], v[192:195], v[152:155], v[68:83]
    v_exp_f32 v136, v120
    v_exp_f32 v137, v121
    v_exp_f32 v138, v122
    v_exp_f32 v139, v123
    v_exp_f32 v140, v124
    v_exp_f32 v141, v125
    v_exp_f32 v142, v126
    v_exp_f32 v143, v127
    v_exp_f32 v144, v128
    v_exp_f32 v145, v129
    v_exp_f32 v146, v130
    v_exp_f32 v147, v131
    v_cvt_pk_bf16_f32 v156, v132, v133
    v_cvt_pk_bf16_f32 v157, v134, v135
    v_cvt_pk_bf16_f32 v158, v136, v137
    v_cvt_pk_bf16_f32 v159, v138, v139
    v_cvt_pk_bf16_f32 v160, v140, v141
    v_cvt_pk_bf16_f32 v161, v142, v143
    v_cvt_pk_bf16_f32 v162, v144, v145
    v_cvt_pk_bf16_f32 v163, v146, v147
    s_nop 1
    v_mfma_f32_32x32x16_bf16 v[84:99], v[188:191], v[156:159], v[84:99]
    v_mfma_f32_32x32x16_bf16 v[84:99], v[192:195], v[160:163], v[84:99]
    s_mov_b32 s40, 0x2b800000
    s_mov_b32 s41, 0x53800000
    s_mov_b64 s[42:43], -1
    s_nop 15
    s_nop 7
    v_cmp_lt_f32 vcc, s40, v48
    s_and_b64 s[42:43], s[42:43], vcc
    v_cmp_gt_f32 vcc, s41, v48
    s_and_b64 s[42:43], s[42:43], vcc
    v_cmp_lt_f32 vcc, s40, v64
    s_and_b64 s[42:43], s[42:43], vcc
    v_cmp_gt_f32 vcc, s41, v64
    s_and_b64 s[42:43], s[42:43], vcc
    v_cmp_lt_f32 vcc, s40, v80
    s_and_b64 s[42:43], s[42:43], vcc
    v_cmp_gt_f32 vcc, s41, v80
    s_and_b64 s[42:43], s[42:43], vcc
    v_cmp_lt_f32 vcc, s40, v96
    s_and_b64 s[42:43], s[42:43], vcc
    v_cmp_gt_f32 vcc, s41, v96
    s_and_b64 s[42:43], s[42:43], vcc
    s_cmp_eq_u32 s43, -1
    s_cbranch_scc0 K2_SAFE
    s_branch K2_FIN
K2_SAFE:
    s_waitcnt vmcnt(0)
    s_sub_u32 s27, s27, 16384
    s_sub_u32 s29, s29, 16384
    buffer_load_dwordx4 v[164:167], v3, s[12:15], s27 offen
    buffer_load_dwordx4 v[168:171], v3, s[12:15], s27 offen offset:1024
    buffer_load_dwordx4 v[172:175], v3, s[12:15], s29 offen
    buffer_load_dwordx4 v[176:179], v3, s[12:15], s29 offen offset:1024
    s_add_u32 s27, s27, 2048
    s_add_u32 s29, s29, 2048
    buffer_load_dwordx4 v[180:183], v3, s[12:15], s27 offen
    buffer_load_dwordx4 v[184:187], v3, s[12:15], s27 offen offset:1024
    buffer_load_dwordx4 v[188:191], v3, s[12:15], s29 offen
    buffer_load_dwordx4 v[192:195], v3, s[12:15], s29 offen offset:1024
    s_add_u32 s27, s27, 2048
    s_add_u32 s29, s29, 2048
    v_mov_b32 v36, 0
    v_mov_b32 v37, 0
    v_mov_b32 v38, 0
    v_mov_b32 v39, 0
    v_mov_b32 v40, 0
    v_mov_b32 v41, 0
    v_mov_b32 v42, 0
    v_mov_b32 v43, 0
    v_mov_b32 v44, 0
    v_mov_b32 v45, 0
    v_mov_b32 v46, 0
    v_mov_b32 v47, 0
    v_mov_b32 v48, 0
    v_mov_b32 v49, 0
    v_mov_b32 v50, 0
    v_mov_b32 v51, 0
    v_mov_b32 v52, 0
    v_mov_b32 v53, 0
    v_mov_b32 v54, 0
    v_mov_b32 v55, 0
    v_mov_b32 v56, 0
    v_mov_b32 v57, 0
    v_mov_b32 v58, 0
    v_mov_b32 v59, 0
    v_mov_b32 v60, 0
    v_mov_b32 v61, 0
    v_mov_b32 v62, 0
    v_mov_b32 v63, 0
    v_mov_b32 v64, 0
    v_mov_b32 v65, 0
    v_mov_b32 v66, 0
    v_mov_b32 v67, 0
    v_mov_b32 v68, 0
    v_mov_b32 v69, 0
    v_mov_b32 v70, 0
    v_mov_b32 v71, 0
    v_mov_b32 v72, 0
    v_mov_b32 v73, 0
    v_mov_b32 v74, 0
    v_mov_b32 v75, 0
    v_mov_b32 v76, 0
    v_mov_b32 v77, 0
    v_mov_b32 v78, 0
    v_mov_b32 v79, 0
    v_mov_b32 v80, 0
    v_mov_b32 v81, 0
    v_mov_b32 v82, 0
    v_mov_b32 v83, 0
    v_mov_b32 v84, 0
    v_mov_b32 v85, 0
    v_mov_b32 v86, 0
    v_mov_b32 v87, 0
    v_mov_b32 v88, 0
    v_mov_b32 v89, 0
    v_mov_b32 v90, 0
    v_mov_b32 v91, 0
    v_mov_b32 v92, 0
    v_mov_b32 v93, 0
    v_mov_b32 v94, 0
    v_mov_b32 v95, 0
    v_mov_b32 v96, 0
    v_mov_b32 v97, 0
    v_mov_b32 v98, 0
    v_mov_b32 v99, 0
    s_waitcnt vmcnt(4)
    v_mfma_f32_32x32x16_bf16 v[100:115], v[164:167], v[4:7], 0
    v_mfma_f32_32x32x16_bf16 v[100:115], v[168:171], v[8:11], v[100:115]
    v_mfma_f32_32x32x16_bf16 v[116:131], v[164:167], v[12:15], 0
    v_mfma_f32_32x32x16_bf16 v[116:131], v[168:171], v[16:19], v[116:131]
    s_nop 15
    s_nop 3
    s_branch K2_R0
K2_B0:
    v_mfma_f32_32x32x16_bf16 v[100:115], v[164:167], v[20:23], 0
    v_mfma_f32_32x32x16_bf16 v[100:115], v[168:171], v[24:27], v[100:115]
    v_mfma_f32_32x32x16_bf16 v[36:51], v[172:175], v[148:151], v[36:51]
    v_mfma_f32_32x32x16_bf16 v[36:51], v[176:179], v[152:155], v[36:51]
    s_branch K2_R1
K2_B1:
    buffer_load_dwordx4 v[196:199], v3, s[12:15], s27 offen
    buffer_load_dwordx4 v[200:203], v3, s[12:15], s27 offen offset:1024
    buffer_load_dwordx4 v[204:207], v3, s[12:15], s29 offen
    buffer_load_dwordx4 v[208:211], v3, s[12:15], s29 offen offset:1024
    s_add_u32 s27, s27, 2048
    s_add_u32 s29, s29, 2048
    v_mfma_f32_32x32x16_bf16 v[116:131], v[164:167], v[28:31], 0
    v_mfma_f32_32x32x16_bf16 v[116:131], v[168:171], v[32:35], v[116:131]
    v_mfma_f32_32x32x16_bf16 v[52:67], v[172:175], v[156:159], v[52:67]
    v_mfma_f32_32x32x16_bf16 v[52:67], v[176:179], v[160:163], v[52:67]
    s_branch K2_R2
K2_B2:
    s_waitcnt vmcnt(4)
    v_mfma_f32_32x32x16_bf16 v[100:115], v[180:183], v[4:7], 0
    v_mfma_f32_32x32x16_bf16 v[100:115], v[184:187], v[8:11], v[100:115]
    v_mfma_f32_32x32x16_bf16 v[68:83], v[172:175], v[148:151], v[68:83]
    v_mfma_f32_32x32x16_bf16 v[68:83], v[176:179], v[152:155], v[68:83]
    s_branch K2_R3
K2_B3:
    v_mfma_f32_32x32x16_bf16 v[116:131], v[180:183], v[12:15], 0
    v_exp_f32 v132, v100
    v_exp_f32 v133, v101
    v_exp_f32 v134, v102
    v_exp_f32 v135, v103
    v_mfma_f32_32x32x16_bf16 v[116:131], v[184:187], v[16:19], v[116:131]
    v_exp_f32 v136, v104
    v_exp_f32 v137, v105
    v_exp_f32 v138, v106
    v_exp_f32 v139, v107
    v_mfma_f32_32x32x16_bf16 v[84:99], v[172:175], v[156:159], v[84:99]
    v_exp_f32 v140, v108
    v_exp_f32 v141, v109
    v_exp_f32 v142, v110
    v_exp_f32 v143, v111
    v_mfma_f32_32x32x16_bf16 v[84:99], v[176:179], v[160:163], v[84:99]
    v_exp_f32 v144, v112
    v_exp_f32 v145, v113
    v_exp_f32 v146, v114
    v_exp_f32 v147, v115
    v_cvt_pk_bf16_f32 v148, v132, v133
    v_cvt_pk_bf16_f32 v149, v134, v135
    v_cvt_pk_bf16_f32 v150, v136, v137
    v_cvt_pk_bf16_f32 v151, v138, v139
    v_cvt_pk_bf16_f32 v152, v140, v141
    v_cvt_pk_bf16_f32 v153, v142, v143
    v_cvt_pk_bf16_f32 v154, v144, v145
    v_cvt_pk_bf16_f32 v155, v146, v147
    v_or3_b32 v217, v148, v149, v150
    v_or3_b32 v218, v151, v152, v153
    v_or3_b32 v217, v217, v154, v155
    v_or_b32 v217, v217, v218
    v_and_b32 v217, s37, v217
    v_cmp_ne_u32 vcc, 0, v217
    s_nop 0
    s_cbranch_vccnz K2_R4
K2_B4:
    v_mfma_f32_32x32x16_bf16 v[100:115], v[180:183], v[20:23], 0
    v_exp_f32 v132, v116
    v_exp_f32 v133, v117
    v_exp_f32 v134, v118
    v_exp_f32 v135, v119
    v_mfma_f32_32x32x16_bf16 v[100:115], v[184:187], v[24:27], v[100:115]
    v_exp_f32 v136, v120
    v_exp_f32 v137, v121
    v_exp_f32 v138, v122
    v_exp_f32 v139, v123
    v_mfma_f32_32x32x16_bf16 v[36:51], v[188:191], v[148:151], v[36:51]
    v_exp_f32 v140, v124
    v_exp_f32 v141, v125
    v_exp_f32 v142, v126
    v_exp_f32 v143, v127
    v_mfma_f32_32x32x16_bf16 v[36:51], v[192:195], v[152:155], v[36:51]
    v_exp_f32 v144, v128
    v_exp_f32 v145, v129
    v_exp_f32 v146, v130
    v_exp_f32 v147, v131
    v_cvt_pk_bf16_f32 v156, v132, v133
    v_cvt_pk_bf16_f32 v157, v134, v135
    v_cvt_pk_bf16_f32 v158, v136, v137
    v_cvt_pk_bf16_f32 v159, v138, v139
    v_cvt_pk_bf16_f32 v160, v140, v141
    v_cvt_pk_bf16_f32 v161, v142, v143
    v_cvt_pk_bf16_f32 v162, v144, v145
    v_cvt_pk_bf16_f32 v163, v146, v147
    v_or3_b32 v217, v156, v157, v158
    v_or3_b32 v218, v159, v160, v161
    v_or3_b32 v217, v217, v162, v163
    v_or_b32 v217, v217, v218
    v_and_b32 v217, s37, v217
    v_cmp_ne_u32 vcc, 0, v217
    buffer_load_dwordx4 v[164:167], v3, s[12:15], s27 offen
    buffer_load_dwordx4 v[168:171], v3, s[12:15], s27 offen offset:1024
    buffer_load_dwordx4 v[172:175], v3, s[12:15], s29 offen
    buffer_load_dwordx4 v[176:179], v3, s[12:15], s29 offen offset:1024
    s_add_u32 s27, s27, 2048
    s_add_u32 s29, s29, 2048
    s_cbranch_vccnz K2_R5
K2_B5:
    v_mfma_f32_32x32x16_bf16 v[116:131], v[180:183], v[28:31], 0
    v_exp_f32 v132, v100
    v_exp_f32 v133, v101
    v_exp_f32 v134, v102
    v_exp_f32 v135, v103
    v_mfma_f32_32x32x16_bf16 v[116:131], v[184:187], v[32:35], v[116:131]
    v_exp_f32 v136, v104
    v_exp_f32 v137, v105
    v_exp_f32 v138, v106
    v_exp_f32 v139, v107
    v_mfma_f32_32x32x16_bf16 v[52:67], v[188:191], v[156:159], v[52:67]
    v_exp_f32 v140, v108
    v_exp_f32 v141, v109
    v_exp_f32 v142, v110
    v_exp_f32 v143, v111
    v_mfma_f32_32x32x16_bf16 v[52:67], v[192:195], v[160:163], v[52:67]
    v_exp_f32 v144, v112
    v_exp_f32 v145, v113
    v_exp_f32 v146, v114
    v_exp_f32 v147, v115
    v_cvt_pk_bf16_f32 v148, v132, v133
    v_cvt_pk_bf16_f32 v149, v134, v135
    v_cvt_pk_bf16_f32 v150, v136, v137
    v_cvt_pk_bf16_f32 v151, v138, v139
    v_cvt_pk_bf16_f32 v152, v140, v141
    v_cvt_pk_bf16_f32 v153, v142, v143
    v_cvt_pk_bf16_f32 v154, v144, v145
    v_cvt_pk_bf16_f32 v155, v146, v147
    v_or3_b32 v217, v148, v149, v150
    v_or3_b32 v218, v151, v152, v153
    v_or3_b32 v217, v217, v154, v155
    v_or_b32 v217, v217, v218
    v_and_b32 v217, s37, v217
    v_cmp_ne_u32 vcc, 0, v217
    s_nop 0
    s_cbranch_vccnz K2_R6
K2_B6:
    s_waitcnt vmcnt(4)
    v_mfma_f32_32x32x16_bf16 v[100:115], v[196:199], v[4:7], 0
    v_exp_f32 v132, v116
    v_exp_f32 v133, v117
    v_exp_f32 v134, v118
    v_exp_f32 v135, v119
    v_mfma_f32_32x32x16_bf16 v[100:115], v[200:203], v[8:11], v[100:115]
    v_exp_f32 v136, v120
    v_exp_f32 v137, v121
    v_exp_f32 v138, v122
    v_exp_f32 v139, v123
    v_mfma_f32_32x32x16_bf16 v[68:83], v[188:191], v[148:151], v[68:83]
    v_exp_f32 v140, v124
    v_exp_f32 v141, v125
    v_exp_f32 v142, v126
    v_exp_f32 v143, v127
    v_mfma_f32_32x32x16_bf16 v[68:83], v[192:195], v[152:155], v[68:83]
    v_exp_f32 v144, v128
    v_exp_f32 v145, v129
    v_exp_f32 v146, v130
    v_exp_f32 v147, v131
    v_cvt_pk_bf16_f32 v156, v132, v133
    v_cvt_pk_bf16_f32 v157, v134, v135
    v_cvt_pk_bf16_f32 v158, v136, v137
    v_cvt_pk_bf16_f32 v159, v138, v139
    v_cvt_pk_bf16_f32 v160, v140, v141
    v_cvt_pk_bf16_f32 v161, v142, v143
    v_cvt_pk_bf16_f32 v162, v144, v145
    v_cvt_pk_bf16_f32 v163, v146, v147
    v_or3_b32 v217, v156, v157, v158
    v_or3_b32 v218, v159, v160, v161
    v_or3_b32 v217, v217, v162, v163
    v_or_b32 v217, v217, v218
    v_and_b32 v217, s37, v217
    v_cmp_ne_u32 vcc, 0, v217
    s_nop 0
    s_cbranch_vccnz K2_R7
K2_B7:
    v_mfma_f32_32x32x16_bf16 v[116:131], v[196:199], v[12:15], 0
    v_exp_f32 v132, v100
    v_exp_f32 v133, v101
    v_exp_f32 v134, v102
    v_exp_f32 v135, v103
    v_mfma_f32_32x32x16_bf16 v[116:131], v[200:203], v[16:19], v[116:131]
    v_exp_f32 v136, v104
    v_exp_f32 v137, v105
    v_exp_f32 v138, v106
    v_exp_f32 v139, v107
    v_mfma_f32_32x32x16_bf16 v[84:99], v[188:191], v[156:159], v[84:99]
    v_exp_f32 v140, v108
    v_exp_f32 v141, v109
    v_exp_f32 v142, v110
    v_exp_f32 v143, v111
    v_mfma_f32_32x32x16_bf16 v[84:99], v[192:195], v[160:163], v[84:99]
    v_exp_f32 v144, v112
    v_exp_f32 v145, v113
    v_exp_f32 v146, v114
    v_exp_f32 v147, v115
    v_cvt_pk_bf16_f32 v148, v132, v133
    v_cvt_pk_bf16_f32 v149, v134, v135
    v_cvt_pk_bf16_f32 v150, v136, v137
    v_cvt_pk_bf16_f32 v151, v138, v139
    v_cvt_pk_bf16_f32 v152, v140, v141
    v_cvt_pk_bf16_f32 v153, v142, v143
    v_cvt_pk_bf16_f32 v154, v144, v145
    v_cvt_pk_bf16_f32 v155, v146, v147
    v_or3_b32 v217, v148, v149, v150
    v_or3_b32 v218, v151, v152, v153
    v_or3_b32 v217, v217, v154, v155
    v_or_b32 v217, v217, v218
    v_and_b32 v217, s37, v217
    v_cmp_ne_u32 vcc, 0, v217
    s_nop 0
    s_cbranch_vccnz K2_R8
K2_B8:
    v_mfma_f32_32x32x16_bf16 v[100:115], v[196:199], v[20:23], 0
    v_exp_f32 v132, v116
    v_exp_f32 v133, v117
    v_exp_f32 v134, v118
    v_exp_f32 v135, v119
    v_mfma_f32_32x32x16_bf16 v[100:115], v[200:203], v[24:27], v[100:115]
    v_exp_f32 v136, v120
    v_exp_f32 v137, v121
    v_exp_f32 v138, v122
    v_exp_f32 v139, v123
    v_mfma_f32_32x32x16_bf16 v[36:51], v[204:207], v[148:151], v[36:51]
    v_exp_f32 v140, v124
    v_exp_f32 v141, v125
    v_exp_f32 v142, v126
    v_exp_f32 v143, v127
    v_mfma_f32_32x32x16_bf16 v[36:51], v[208:211], v[152:155], v[36:51]
    v_exp_f32 v144, v128
    v_exp_f32 v145, v129
    v_exp_f32 v146, v130
    v_exp_f32 v147, v131
    v_cvt_pk_bf16_f32 v156, v132, v133
    v_cvt_pk_bf16_f32 v157, v134, v135
    v_cvt_pk_bf16_f32 v158, v136, v137
    v_cvt_pk_bf16_f32 v159, v138, v139
    v_cvt_pk_bf16_f32 v160, v140, v141
    v_cvt_pk_bf16_f32 v161, v142, v143
    v_cvt_pk_bf16_f32 v162, v144, v145
    v_cvt_pk_bf16_f32 v163, v146, v147
    v_or3_b32 v217, v156, v157, v158
    v_or3_b32 v218, v159, v160, v161
    v_or3_b32 v217, v217, v162, v163
    v_or_b32 v217, v217, v218
    v_and_b32 v217, s37, v217
    v_cmp_ne_u32 vcc, 0, v217
    buffer_load_dwordx4 v[180:183], v3, s[12:15], s27 offen
    buffer_load_dwordx4 v[184:187], v3, s[12:15], s27 offen offset:1024
    buffer_load_dwordx4 v[188:191], v3, s[12:15], s29 offen
    buffer_load_dwordx4 v[192:195], v3, s[12:15], s29 offen offset:1024
    s_add_u32 s27, s27, 2048
    s_add_u32 s29, s29, 2048
    s_cbranch_vccnz K2_R9
K2_B9:
    v_mfma_f32_32x32x16_bf16 v[116:131], v[196:199], v[28:31], 0
    v_exp_f32 v132, v100
    v_exp_f32 v133, v101
    v_exp_f32 v134, v102
    v_exp_f32 v135, v103
    v_mfma_f32_32x32x16_bf16 v[116:131], v[200:203], v[32:35], v[116:131]
    v_exp_f32 v136, v104
    v_exp_f32 v137, v105
    v_exp_f32 v138, v106
    v_exp_f32 v139, v107
    v_mfma_f32_32x32x16_bf16 v[52:67], v[204:207], v[156:159], v[52:67]
    v_exp_f32 v140, v108
    v_exp_f32 v141, v109
    v_exp_f32 v142, v110
    v_exp_f32 v143, v111
    v_mfma_f32_32x32x16_bf16 v[52:67], v[208:211], v[160:163], v[52:67]
    v_exp_f32 v144, v112
    v_exp_f32 v145, v113
    v_exp_f32 v146, v114
    v_exp_f32 v147, v115
    v_cvt_pk_bf16_f32 v148, v132, v133
    v_cvt_pk_bf16_f32 v149, v134, v135
    v_cvt_pk_bf16_f32 v150, v136, v137
    v_cvt_pk_bf16_f32 v151, v138, v139
    v_cvt_pk_bf16_f32 v152, v140, v141
    v_cvt_pk_bf16_f32 v153, v142, v143
    v_cvt_pk_bf16_f32 v154, v144, v145
    v_cvt_pk_bf16_f32 v155, v146, v147
    v_or3_b32 v217, v148, v149, v150
    v_or3_b32 v218, v151, v152, v153
    v_or3_b32 v217, v217, v154, v155
    v_or_b32 v217, v217, v218
    v_and_b32 v217, s37, v217
    v_cmp_ne_u32 vcc, 0, v217
    s_nop 0
    s_cbranch_vccnz K2_R10
K2_B10:
    s_waitcnt vmcnt(4)
    v_mfma_f32_32x32x16_bf16 v[100:115], v[164:167], v[4:7], 0
    v_exp_f32 v132, v116
    v_exp_f32 v133, v117
    v_exp_f32 v134, v118
    v_exp_f32 v135, v119
    v_mfma_f32_32x32x16_bf16 v[100:115], v[168:171], v[8:11], v[100:115]
    v_exp_f32 v136, v120
    v_exp_f32 v137, v121
    v_exp_f32 v138, v122
    v_exp_f32 v139, v123
    v_mfma_f32_32x32x16_bf16 v[68:83], v[204:207], v[148:151], v[68:83]
    v_exp_f32 v140, v124
    v_exp_f32 v141, v125
    v_exp_f32 v142, v126
    v_exp_f32 v143, v127
    v_mfma_f32_32x32x16_bf16 v[68:83], v[208:211], v[152:155], v[68:83]
    v_exp_f32 v144, v128
    v_exp_f32 v145, v129
    v_exp_f32 v146, v130
    v_exp_f32 v147, v131
    v_cvt_pk_bf16_f32 v156, v132, v133
    v_cvt_pk_bf16_f32 v157, v134, v135
    v_cvt_pk_bf16_f32 v158, v136, v137
    v_cvt_pk_bf16_f32 v159, v138, v139
    v_cvt_pk_bf16_f32 v160, v140, v141
    v_cvt_pk_bf16_f32 v161, v142, v143
    v_cvt_pk_bf16_f32 v162, v144, v145
    v_cvt_pk_bf16_f32 v163, v146, v147
    v_or3_b32 v217, v156, v157, v158
    v_or3_b32 v218, v159, v160, v161
    v_or3_b32 v217, v217, v162, v163
    v_or_b32 v217, v217, v218
    v_and_b32 v217, s37, v217
    v_cmp_ne_u32 vcc, 0, v217
    s_nop 0
    s_cbranch_vccnz K2_R11
K2_B11:
    v_mfma_f32_32x32x16_bf16 v[116:131], v[164:167], v[12:15], 0
    v_exp_f32 v132, v100
    v_exp_f32 v133, v101
    v_exp_f32 v134, v102
    v_exp_f32 v135, v103
    v_mfma_f32_32x32x16_bf16 v[116:131], v[168:171], v[16:19], v[116:131]
    v_exp_f32 v136, v104
    v_exp_f32 v137, v105
    v_exp_f32 v138, v106
    v_exp_f32 v139, v107
    v_mfma_f32_32x32x16_bf16 v[84:99], v[204:207], v[156:159], v[84:99]
    v_exp_f32 v140, v108
    v_exp_f32 v141, v109
    v_exp_f32 v142, v110
    v_exp_f32 v143, v111
    v_mfma_f32_32x32x16_bf16 v[84:99], v[208:211], v[160:163], v[84:99]
    v_exp_f32 v144, v112
    v_exp_f32 v145, v113
    v_exp_f32 v146, v114
    v_exp_f32 v147, v115
    v_cvt_pk_bf16_f32 v148, v132, v133
    v_cvt_pk_bf16_f32 v149, v134, v135
    v_cvt_pk_bf16_f32 v150, v136, v137
    v_cvt_pk_bf16_f32 v151, v138, v139
    v_cvt_pk_bf16_f32 v152, v140, v141
    v_cvt_pk_bf16_f32 v153, v142, v143
    v_cvt_pk_bf16_f32 v154, v144, v145
    v_cvt_pk_bf16_f32 v155, v146, v147
    v_or3_b32 v217, v148, v149, v150
    v_or3_b32 v218, v151, v152, v153
    v_or3_b32 v217, v217, v154, v155
    v_or_b32 v217, v217, v218
    v_and_b32 v217, s37, v217
    v_cmp_ne_u32 vcc, 0, v217
    s_nop 0
    s_cbranch_vccnz K2_R12
K2_B12:
    v_mfma_f32_32x32x16_bf16 v[100:115], v[164:167], v[20:23], 0
    v_exp_f32 v132, v116
    v_exp_f32 v133, v117
    v_exp_f32 v134, v118
    v_exp_f32 v135, v119
    v_mfma_f32_32x32x16_bf16 v[100:115], v[168:171], v[24:27], v[100:115]
    v_exp_f32 v136, v120
    v_exp_f32 v137, v121
    v_exp_f32 v138, v122
    v_exp_f32 v139, v123
    v_mfma_f32_32x32x16_bf16 v[36:51], v[172:175], v[148:151], v[36:51]
    v_exp_f32 v140, v124
    v_exp_f32 v141, v125
    v_exp_f32 v142, v126
    v_exp_f32 v143, v127
    v_mfma_f32_32x32x16_bf16 v[36:51], v[176:179], v[152:155], v[36:51]
    v_exp_f32 v144, v128
    v_exp_f32 v145, v129
    v_exp_f32 v146, v130
    v_exp_f32 v147, v131
    v_cvt_pk_bf16_f32 v156, v132, v133
    v_cvt_pk_bf16_f32 v157, v134, v135
    v_cvt_pk_bf16_f32 v158, v136, v137
    v_cvt_pk_bf16_f32 v159, v138, v139
    v_cvt_pk_bf16_f32 v160, v140, v141
    v_cvt_pk_bf16_f32 v161, v142, v143
    v_cvt_pk_bf16_f32 v162, v144, v145
    v_cvt_pk_bf16_f32 v163, v146, v147
    v_or3_b32 v217, v156, v157, v158
    v_or3_b32 v218, v159, v160, v161
    v_or3_b32 v217, v217, v162, v163
    v_or_b32 v217, v217, v218
    v_and_b32 v217, s37, v217
    v_cmp_ne_u32 vcc, 0, v217
    buffer_load_dwordx4 v[196:199], v3, s[12:15], s27 offen
    buffer_load_dwordx4 v[200:203], v3, s[12:15], s27 offen offset:1024
    buffer_load_dwordx4 v[204:207], v3, s[12:15], s29 offen
    buffer_load_dwordx4 v[208:211], v3, s[12:15], s29 offen offset:1024
    s_add_u32 s27, s27, 2048
    s_add_u32 s29, s29, 2048
    s_cbranch_vccnz K2_R13
K2_B13:
    v_mfma_f32_32x32x16_bf16 v[116:131], v[164:167], v[28:31], 0
    v_exp_f32 v132, v100
    v_exp_f32 v133, v101
    v_exp_f32 v134, v102
    v_exp_f32 v135, v103
    v_mfma_f32_32x32x16_bf16 v[116:131], v[168:171], v[32:35], v[116:131]
    v_exp_f32 v136, v104
    v_exp_f32 v137, v105
    v_exp_f32 v138, v106
    v_exp_f32 v139, v107
    v_mfma_f32_32x32x16_bf16 v[52:67], v[172:175], v[156:159], v[52:67]
    v_exp_f32 v140, v108
    v_exp_f32 v141, v109
    v_exp_f32 v142, v110
    v_exp_f32 v143, v111
    v_mfma_f32_32x32x16_bf16 v[52:67], v[176:179], v[160:163], v[52:67]
    v_exp_f32 v144, v112
    v_exp_f32 v145, v113
    v_exp_f32 v146, v114
    v_exp_f32 v147, v115
    v_cvt_pk_bf16_f32 v148, v132, v133
    v_cvt_pk_bf16_f32 v149, v134, v135
    v_cvt_pk_bf16_f32 v150, v136, v137
    v_cvt_pk_bf16_f32 v151, v138, v139
    v_cvt_pk_bf16_f32 v152, v140, v141
    v_cvt_pk_bf16_f32 v153, v142, v143
    v_cvt_pk_bf16_f32 v154, v144, v145
    v_cvt_pk_bf16_f32 v155, v146, v147
    v_or3_b32 v217, v148, v149, v150
    v_or3_b32 v218, v151, v152, v153
    v_or3_b32 v217, v217, v154, v155
    v_or_b32 v217, v217, v218
    v_and_b32 v217, s37, v217
    v_cmp_ne_u32 vcc, 0, v217
    s_nop 0
    s_cbranch_vccnz K2_R14
K2_B14:
    s_waitcnt vmcnt(4)
    v_mfma_f32_32x32x16_bf16 v[100:115], v[180:183], v[4:7], 0
    v_exp_f32 v132, v116
    v_exp_f32 v133, v117
    v_exp_f32 v134, v118
    v_exp_f32 v135, v119
    v_mfma_f32_32x32x16_bf16 v[100:115], v[184:187], v[8:11], v[100:115]
    v_exp_f32 v136, v120
    v_exp_f32 v137, v121
    v_exp_f32 v138, v122
    v_exp_f32 v139, v123
    v_mfma_f32_32x32x16_bf16 v[68:83], v[172:175], v[148:151], v[68:83]
    v_exp_f32 v140, v124
    v_exp_f32 v141, v125
    v_exp_f32 v142, v126
    v_exp_f32 v143, v127
    v_mfma_f32_32x32x16_bf16 v[68:83], v[176:179], v[152:155], v[68:83]
    v_exp_f32 v144, v128
    v_exp_f32 v145, v129
    v_exp_f32 v146, v130
    v_exp_f32 v147, v131
    v_cvt_pk_bf16_f32 v156, v132, v133
    v_cvt_pk_bf16_f32 v157, v134, v135
    v_cvt_pk_bf16_f32 v158, v136, v137
    v_cvt_pk_bf16_f32 v159, v138, v139
    v_cvt_pk_bf16_f32 v160, v140, v141
    v_cvt_pk_bf16_f32 v161, v142, v143
    v_cvt_pk_bf16_f32 v162, v144, v145
    v_cvt_pk_bf16_f32 v163, v146, v147
    v_or3_b32 v217, v156, v157, v158
    v_or3_b32 v218, v159, v160, v161
    v_or3_b32 v217, v217, v162, v163
    v_or_b32 v217, v217, v218
    v_and_b32 v217, s37, v217
    v_cmp_ne_u32 vcc, 0, v217
    s_nop 0
    s_cbranch_vccnz K2_R15
K2_B15:
    v_mfma_f32_32x32x16_bf16 v[116:131], v[180:183], v[12:15], 0
    v_exp_f32 v132, v100
    v_exp_f32 v133, v101
    v_exp_f32 v134, v102
    v_exp_f32 v135, v103
    v_mfma_f32_32x32x16_bf16 v[116:131], v[184:187], v[16:19], v[116:131]
    v_exp_f32 v136, v104
    v_exp_f32 v137, v105
    v_exp_f32 v138, v106
    v_exp_f32 v139, v107
    v_mfma_f32_32x32x16_bf16 v[84:99], v[172:175], v[156:159], v[84:99]
    v_exp_f32 v140, v108
    v_exp_f32 v141, v109
    v_exp_f32 v142, v110
    v_exp_f32 v143, v111
    v_mfma_f32_32x32x16_bf16 v[84:99], v[176:179], v[160:163], v[84:99]
    v_exp_f32 v144, v112
    v_exp_f32 v145, v113
    v_exp_f32 v146, v114
    v_exp_f32 v147, v115
    v_cvt_pk_bf16_f32 v148, v132, v133
    v_cvt_pk_bf16_f32 v149, v134, v135
    v_cvt_pk_bf16_f32 v150, v136, v137
    v_cvt_pk_bf16_f32 v151, v138, v139
    v_cvt_pk_bf16_f32 v152, v140, v141
    v_cvt_pk_bf16_f32 v153, v142, v143
    v_cvt_pk_bf16_f32 v154, v144, v145
    v_cvt_pk_bf16_f32 v155, v146, v147
    v_or3_b32 v217, v148, v149, v150
    v_or3_b32 v218, v151, v152, v153
    v_or3_b32 v217, v217, v154, v155
    v_or_b32 v217, v217, v218
    v_and_b32 v217, s37, v217
    v_cmp_ne_u32 vcc, 0, v217
    s_nop 0
    s_cbranch_vccnz K2_R16
K2_B16:
    v_mfma_f32_32x32x16_bf16 v[100:115], v[180:183], v[20:23], 0
    v_exp_f32 v132, v116
    v_exp_f32 v133, v117
    v_exp_f32 v134, v118
    v_exp_f32 v135, v119
    v_mfma_f32_32x32x16_bf16 v[100:115], v[184:187], v[24:27], v[100:115]
    v_exp_f32 v136, v120
    v_exp_f32 v137, v121
    v_exp_f32 v138, v122
    v_exp_f32 v139, v123
    v_mfma_f32_32x32x16_bf16 v[36:51], v[188:191], v[148:151], v[36:51]
    v_exp_f32 v140, v124
    v_exp_f32 v141, v125
    v_exp_f32 v142, v126
    v_exp_f32 v143, v127
    v_mfma_f32_32x32x16_bf16 v[36:51], v[192:195], v[152:155], v[36:51]
    v_exp_f32 v144, v128
    v_exp_f32 v145, v129
    v_exp_f32 v146, v130
    v_exp_f32 v147, v131
    v_cvt_pk_bf16_f32 v156, v132, v133
    v_cvt_pk_bf16_f32 v157, v134, v135
    v_cvt_pk_bf16_f32 v158, v136, v137
    v_cvt_pk_bf16_f32 v159, v138, v139
    v_cvt_pk_bf16_f32 v160, v140, v141
    v_cvt_pk_bf16_f32 v161, v142, v143
    v_cvt_pk_bf16_f32 v162, v144, v145
    v_cvt_pk_bf16_f32 v163, v146, v147
    v_or3_b32 v217, v156, v157, v158
    v_or3_b32 v218, v159, v160, v161
    v_or3_b32 v217, v217, v162, v163
    v_or_b32 v217, v217, v218
    v_and_b32 v217, s37, v217
    v_cmp_ne_u32 vcc, 0, v217
    buffer_load_dwordx4 v[164:167], v3, s[12:15], s27 offen
    buffer_load_dwordx4 v[168:171], v3, s[12:15], s27 offen offset:1024
    buffer_load_dwordx4 v[172:175], v3, s[12:15], s29 offen
    buffer_load_dwordx4 v[176:179], v3, s[12:15], s29 offen offset:1024
    s_add_u32 s27, s27, 2048
    s_add_u32 s29, s29, 2048
    s_cbranch_vccnz K2_R17
K2_B17:
    v_mfma_f32_32x32x16_bf16 v[116:131], v[180:183], v[28:31], 0
    v_exp_f32 v132, v100
    v_exp_f32 v133, v101
    v_exp_f32 v134, v102
    v_exp_f32 v135, v103
    v_mfma_f32_32x32x16_bf16 v[116:131], v[184:187], v[32:35], v[116:131]
    v_exp_f32 v136, v104
    v_exp_f32 v137, v105
    v_exp_f32 v138, v106
    v_exp_f32 v139, v107
    v_mfma_f32_32x32x16_bf16 v[52:67], v[188:191], v[156:159], v[52:67]
    v_exp_f32 v140, v108
    v_exp_f32 v141, v109
    v_exp_f32 v142, v110
    v_exp_f32 v143, v111
    v_mfma_f32_32x32x16_bf16 v[52:67], v[192:195], v[160:163], v[52:67]
    v_exp_f32 v144, v112
    v_exp_f32 v145, v113
    v_exp_f32 v146, v114
    v_exp_f32 v147, v115
    v_cvt_pk_bf16_f32 v148, v132, v133
    v_cvt_pk_bf16_f32 v149, v134, v135
    v_cvt_pk_bf16_f32 v150, v136, v137
    v_cvt_pk_bf16_f32 v151, v138, v139
    v_cvt_pk_bf16_f32 v152, v140, v141
    v_cvt_pk_bf16_f32 v153, v142, v143
    v_cvt_pk_bf16_f32 v154, v144, v145
    v_cvt_pk_bf16_f32 v155, v146, v147
    v_or3_b32 v217, v148, v149, v150
    v_or3_b32 v218, v151, v152, v153
    v_or3_b32 v217, v217, v154, v155
    v_or_b32 v217, v217, v218
    v_and_b32 v217, s37, v217
    v_cmp_ne_u32 vcc, 0, v217
    s_nop 0
    s_cbranch_vccnz K2_R18
K2_B18:
    s_waitcnt vmcnt(4)
    v_mfma_f32_32x32x16_bf16 v[100:115], v[196:199], v[4:7], 0
    v_exp_f32 v132, v116
    v_exp_f32 v133, v117
    v_exp_f32 v134, v118
    v_exp_f32 v135, v119
    v_mfma_f32_32x32x16_bf16 v[100:115], v[200:203], v[8:11], v[100:115]
    v_exp_f32 v136, v120
    v_exp_f32 v137, v121
    v_exp_f32 v138, v122
    v_exp_f32 v139, v123
    v_mfma_f32_32x32x16_bf16 v[68:83], v[188:191], v[148:151], v[68:83]
    v_exp_f32 v140, v124
    v_exp_f32 v141, v125
    v_exp_f32 v142, v126
    v_exp_f32 v143, v127
    v_mfma_f32_32x32x16_bf16 v[68:83], v[192:195], v[152:155], v[68:83]
    v_exp_f32 v144, v128
    v_exp_f32 v145, v129
    v_exp_f32 v146, v130
    v_exp_f32 v147, v131
    v_cvt_pk_bf16_f32 v156, v132, v133
    v_cvt_pk_bf16_f32 v157, v134, v135
    v_cvt_pk_bf16_f32 v158, v136, v137
    v_cvt_pk_bf16_f32 v159, v138, v139
    v_cvt_pk_bf16_f32 v160, v140, v141
    v_cvt_pk_bf16_f32 v161, v142, v143
    v_cvt_pk_bf16_f32 v162, v144, v145
    v_cvt_pk_bf16_f32 v163, v146, v147
    v_or3_b32 v217, v156, v157, v158
    v_or3_b32 v218, v159, v160, v161
    v_or3_b32 v217, v217, v162, v163
    v_or_b32 v217, v217, v218
    v_and_b32 v217, s37, v217
    v_cmp_ne_u32 vcc, 0, v217
    s_nop 0
    s_cbranch_vccnz K2_R19
K2_B19:
    v_mfma_f32_32x32x16_bf16 v[116:131], v[196:199], v[12:15], 0
    v_exp_f32 v132, v100
    v_exp_f32 v133, v101
    v_exp_f32 v134, v102
    v_exp_f32 v135, v103
    v_mfma_f32_32x32x16_bf16 v[116:131], v[200:203], v[16:19], v[116:131]
    v_exp_f32 v136, v104
    v_exp_f32 v137, v105
    v_exp_f32 v138, v106
    v_exp_f32 v139, v107
    v_mfma_f32_32x32x16_bf16 v[84:99], v[188:191], v[156:159], v[84:99]
    v_exp_f32 v140, v108
    v_exp_f32 v141, v109
    v_exp_f32 v142, v110
    v_exp_f32 v143, v111
    v_mfma_f32_32x32x16_bf16 v[84:99], v[192:195], v[160:163], v[84:99]
    v_exp_f32 v144, v112
    v_exp_f32 v145, v113
    v_exp_f32 v146, v114
    v_exp_f32 v147, v115
    v_cvt_pk_bf16_f32 v148, v132, v133
    v_cvt_pk_bf16_f32 v149, v134, v135
    v_cvt_pk_bf16_f32 v150, v136, v137
    v_cvt_pk_bf16_f32 v151, v138, v139
    v_cvt_pk_bf16_f32 v152, v140, v141
    v_cvt_pk_bf16_f32 v153, v142, v143
    v_cvt_pk_bf16_f32 v154, v144, v145
    v_cvt_pk_bf16_f32 v155, v146, v147
    v_or3_b32 v217, v148, v149, v150
    v_or3_b32 v218, v151, v152, v153
    v_or3_b32 v217, v217, v154, v155
    v_or_b32 v217, v217, v218
    v_and_b32 v217, s37, v217
    v_cmp_ne_u32 vcc, 0, v217
    s_nop 0
    s_cbranch_vccnz K2_R20
K2_B20:
    v_mfma_f32_32x32x16_bf16 v[100:115], v[196:199], v[20:23], 0
    v_exp_f32 v132, v116
    v_exp_f32 v133, v117
    v_exp_f32 v134, v118
    v_exp_f32 v135, v119
    v_mfma_f32_32x32x16_bf16 v[100:115], v[200:203], v[24:27], v[100:115]
    v_exp_f32 v136, v120
    v_exp_f32 v137, v121
    v_exp_f32 v138, v122
    v_exp_f32 v139, v123
    v_mfma_f32_32x32x16_bf16 v[36:51], v[204:207], v[148:151], v[36:51]
    v_exp_f32 v140, v124
    v_exp_f32 v141, v125
    v_exp_f32 v142, v126
    v_exp_f32 v143, v127
    v_mfma_f32_32x32x16_bf16 v[36:51], v[208:211], v[152:155], v[36:51]
    v_exp_f32 v144, v128
    v_exp_f32 v145, v129
    v_exp_f32 v146, v130
    v_exp_f32 v147, v131
    v_cvt_pk_bf16_f32 v156, v132, v133
    v_cvt_pk_bf16_f32 v157, v134, v135
    v_cvt_pk_bf16_f32 v158, v136, v137
    v_cvt_pk_bf16_f32 v159, v138, v139
    v_cvt_pk_bf16_f32 v160, v140, v141
    v_cvt_pk_bf16_f32 v161, v142, v143
    v_cvt_pk_bf16_f32 v162, v144, v145
    v_cvt_pk_bf16_f32 v163, v146, v147
    v_or3_b32 v217, v156, v157, v158
    v_or3_b32 v218, v159, v160, v161
    v_or3_b32 v217, v217, v162, v163
    v_or_b32 v217, v217, v218
    v_and_b32 v217, s37, v217
    v_cmp_ne_u32 vcc, 0, v217
    buffer_load_dwordx4 v[180:183], v3, s[12:15], s27 offen
    buffer_load_dwordx4 v[184:187], v3, s[12:15], s27 offen offset:1024
    buffer_load_dwordx4 v[188:191], v3, s[12:15], s29 offen
    buffer_load_dwordx4 v[192:195], v3, s[12:15], s29 offen offset:1024
    s_add_u32 s27, s27, 2048
    s_add_u32 s29, s29, 2048
    s_cbranch_vccnz K2_R21
K2_B21:
    v_mfma_f32_32x32x16_bf16 v[116:131], v[196:199], v[28:31], 0
    v_exp_f32 v132, v100
    v_exp_f32 v133, v101
    v_exp_f32 v134, v102
    v_exp_f32 v135, v103
    v_mfma_f32_32x32x16_bf16 v[116:131], v[200:203], v[32:35], v[116:131]
    v_exp_f32 v136, v104
    v_exp_f32 v137, v105
    v_exp_f32 v138, v106
    v_exp_f32 v139, v107
    v_mfma_f32_32x32x16_bf16 v[52:67], v[204:207], v[156:159], v[52:67]
    v_exp_f32 v140, v108
    v_exp_f32 v141, v109
    v_exp_f32 v142, v110
    v_exp_f32 v143, v111
    v_mfma_f32_32x32x16_bf16 v[52:67], v[208:211], v[160:163], v[52:67]
    v_exp_f32 v144, v112
    v_exp_f32 v145, v113
    v_exp_f32 v146, v114
    v_exp_f32 v147, v115
    v_cvt_pk_bf16_f32 v148, v132, v133
    v_cvt_pk_bf16_f32 v149, v134, v135
    v_cvt_pk_bf16_f32 v150, v136, v137
    v_cvt_pk_bf16_f32 v151, v138, v139
    v_cvt_pk_bf16_f32 v152, v140, v141
    v_cvt_pk_bf16_f32 v153, v142, v143
    v_cvt_pk_bf16_f32 v154, v144, v145
    v_cvt_pk_bf16_f32 v155, v146, v147
    v_or3_b32 v217, v148, v149, v150
    v_or3_b32 v218, v151, v152, v153
    v_or3_b32 v217, v217, v154, v155
    v_or_b32 v217, v217, v218
    v_and_b32 v217, s37, v217
    v_cmp_ne_u32 vcc, 0, v217
    s_nop 0
    s_cbranch_vccnz K2_R22
K2_B22:
    s_waitcnt vmcnt(4)
    v_mfma_f32_32x32x16_bf16 v[100:115], v[164:167], v[4:7], 0
    v_exp_f32 v132, v116
    v_exp_f32 v133, v117
    v_exp_f32 v134, v118
    v_exp_f32 v135, v119
    v_mfma_f32_32x32x16_bf16 v[100:115], v[168:171], v[8:11], v[100:115]
    v_exp_f32 v136, v120
    v_exp_f32 v137, v121
    v_exp_f32 v138, v122
    v_exp_f32 v139, v123
    v_mfma_f32_32x32x16_bf16 v[68:83], v[204:207], v[148:151], v[68:83]
    v_exp_f32 v140, v124
    v_exp_f32 v141, v125
    v_exp_f32 v142, v126
    v_exp_f32 v143, v127
    v_mfma_f32_32x32x16_bf16 v[68:83], v[208:211], v[152:155], v[68:83]
    v_exp_f32 v144, v128
    v_exp_f32 v145, v129
    v_exp_f32 v146, v130
    v_exp_f32 v147, v131
    v_cvt_pk_bf16_f32 v156, v132, v133
    v_cvt_pk_bf16_f32 v157, v134, v135
    v_cvt_pk_bf16_f32 v158, v136, v137
    v_cvt_pk_bf16_f32 v159, v138, v139
    v_cvt_pk_bf16_f32 v160, v140, v141
    v_cvt_pk_bf16_f32 v161, v142, v143
    v_cvt_pk_bf16_f32 v162, v144, v145
    v_cvt_pk_bf16_f32 v163, v146, v147
    v_or3_b32 v217, v156, v157, v158
    v_or3_b32 v218, v159, v160, v161
    v_or3_b32 v217, v217, v162, v163
    v_or_b32 v217, v217, v218
    v_and_b32 v217, s37, v217
    v_cmp_ne_u32 vcc, 0, v217
    s_nop 0
    s_cbranch_vccnz K2_R23
K2_B23:
    v_mfma_f32_32x32x16_bf16 v[116:131], v[164:167], v[12:15], 0
    v_exp_f32 v132, v100
    v_exp_f32 v133, v101
    v_exp_f32 v134, v102
    v_exp_f32 v135, v103
    v_mfma_f32_32x32x16_bf16 v[116:131], v[168:171], v[16:19], v[116:131]
    v_exp_f32 v136, v104
    v_exp_f32 v137, v105
    v_exp_f32 v138, v106
    v_exp_f32 v139, v107
    v_mfma_f32_32x32x16_bf16 v[84:99], v[204:207], v[156:159], v[84:99]
    v_exp_f32 v140, v108
    v_exp_f32 v141, v109
    v_exp_f32 v142, v110
    v_exp_f32 v143, v111
    v_mfma_f32_32x32x16_bf16 v[84:99], v[208:211], v[160:163], v[84:99]
    v_exp_f32 v144, v112
    v_exp_f32 v145, v113
    v_exp_f32 v146, v114
    v_exp_f32 v147, v115
    v_cvt_pk_bf16_f32 v148, v132, v133
    v_cvt_pk_bf16_f32 v149, v134, v135
    v_cvt_pk_bf16_f32 v150, v136, v137
    v_cvt_pk_bf16_f32 v151, v138, v139
    v_cvt_pk_bf16_f32 v152, v140, v141
    v_cvt_pk_bf16_f32 v153, v142, v143
    v_cvt_pk_bf16_f32 v154, v144, v145
    v_cvt_pk_bf16_f32 v155, v146, v147
    v_or3_b32 v217, v148, v149, v150
    v_or3_b32 v218, v151, v152, v153
    v_or3_b32 v217, v217, v154, v155
    v_or_b32 v217, v217, v218
    v_and_b32 v217, s37, v217
    v_cmp_ne_u32 vcc, 0, v217
    s_nop 0
    s_cbranch_vccnz K2_R24
K2_B24:
    v_mfma_f32_32x32x16_bf16 v[100:115], v[164:167], v[20:23], 0
    v_exp_f32 v132, v116
    v_exp_f32 v133, v117
    v_exp_f32 v134, v118
    v_exp_f32 v135, v119
    v_mfma_f32_32x32x16_bf16 v[100:115], v[168:171], v[24:27], v[100:115]
    v_exp_f32 v136, v120
    v_exp_f32 v137, v121
    v_exp_f32 v138, v122
    v_exp_f32 v139, v123
    v_mfma_f32_32x32x16_bf16 v[36:51], v[172:175], v[148:151], v[36:51]
    v_exp_f32 v140, v124
    v_exp_f32 v141, v125
    v_exp_f32 v142, v126
    v_exp_f32 v143, v127
    v_mfma_f32_32x32x16_bf16 v[36:51], v[176:179], v[152:155], v[36:51]
    v_exp_f32 v144, v128
    v_exp_f32 v145, v129
    v_exp_f32 v146, v130
    v_exp_f32 v147, v131
    v_cvt_pk_bf16_f32 v156, v132, v133
    v_cvt_pk_bf16_f32 v157, v134, v135
    v_cvt_pk_bf16_f32 v158, v136, v137
    v_cvt_pk_bf16_f32 v159, v138, v139
    v_cvt_pk_bf16_f32 v160, v140, v141
    v_cvt_pk_bf16_f32 v161, v142, v143
    v_cvt_pk_bf16_f32 v162, v144, v145
    v_cvt_pk_bf16_f32 v163, v146, v147
    v_or3_b32 v217, v156, v157, v158
    v_or3_b32 v218, v159, v160, v161
    v_or3_b32 v217, v217, v162, v163
    v_or_b32 v217, v217, v218
    v_and_b32 v217, s37, v217
    v_cmp_ne_u32 vcc, 0, v217
    s_nop 0
    s_cbranch_vccnz K2_R25
K2_B25:
    v_mfma_f32_32x32x16_bf16 v[116:131], v[164:167], v[28:31], 0
    v_exp_f32 v132, v100
    v_exp_f32 v133, v101
    v_exp_f32 v134, v102
    v_exp_f32 v135, v103
    v_mfma_f32_32x32x16_bf16 v[116:131], v[168:171], v[32:35], v[116:131]
    v_exp_f32 v136, v104
    v_exp_f32 v137, v105
    v_exp_f32 v138, v106
    v_exp_f32 v139, v107
    v_mfma_f32_32x32x16_bf16 v[52:67], v[172:175], v[156:159], v[52:67]
    v_exp_f32 v140, v108
    v_exp_f32 v141, v109
    v_exp_f32 v142, v110
    v_exp_f32 v143, v111
    v_mfma_f32_32x32x16_bf16 v[52:67], v[176:179], v[160:163], v[52:67]
    v_exp_f32 v144, v112
    v_exp_f32 v145, v113
    v_exp_f32 v146, v114
    v_exp_f32 v147, v115
    v_cvt_pk_bf16_f32 v148, v132, v133
    v_cvt_pk_bf16_f32 v149, v134, v135
    v_cvt_pk_bf16_f32 v150, v136, v137
    v_cvt_pk_bf16_f32 v151, v138, v139
    v_cvt_pk_bf16_f32 v152, v140, v141
    v_cvt_pk_bf16_f32 v153, v142, v143
    v_cvt_pk_bf16_f32 v154, v144, v145
    v_cvt_pk_bf16_f32 v155, v146, v147
    v_or3_b32 v217, v148, v149, v150
    v_or3_b32 v218, v151, v152, v153
    v_or3_b32 v217, v217, v154, v155
    v_or_b32 v217, v217, v218
    v_and_b32 v217, s37, v217
    v_cmp_ne_u32 vcc, 0, v217
    s_nop 0
    s_cbranch_vccnz K2_R26
K2_B26:
    s_waitcnt vmcnt(0)
    v_mfma_f32_32x32x16_bf16 v[100:115], v[180:183], v[4:7], 0
    v_exp_f32 v132, v116
    v_exp_f32 v133, v117
    v_exp_f32 v134, v118
    v_exp_f32 v135, v119
    v_mfma_f32_32x32x16_bf16 v[100:115], v[184:187], v[8:11], v[100:115]
    v_exp_f32 v136, v120
    v_exp_f32 v137, v121
    v_exp_f32 v138, v122
    v_exp_f32 v139, v123
    v_mfma_f32_32x32x16_bf16 v[68:83], v[172:175], v[148:151], v[68:83]
    v_exp_f32 v140, v124
    v_exp_f32 v141, v125
    v_exp_f32 v142, v126
    v_exp_f32 v143, v127
    v_mfma_f32_32x32x16_bf16 v[68:83], v[176:179], v[152:155], v[68:83]
    v_exp_f32 v144, v128
    v_exp_f32 v145, v129
    v_exp_f32 v146, v130
    v_exp_f32 v147, v131
    v_cvt_pk_bf16_f32 v156, v132, v133
    v_cvt_pk_bf16_f32 v157, v134, v135
    v_cvt_pk_bf16_f32 v158, v136, v137
    v_cvt_pk_bf16_f32 v159, v138, v139
    v_cvt_pk_bf16_f32 v160, v140, v141
    v_cvt_pk_bf16_f32 v161, v142, v143
    v_cvt_pk_bf16_f32 v162, v144, v145
    v_cvt_pk_bf16_f32 v163, v146, v147
    v_or3_b32 v217, v156, v157, v158
    v_or3_b32 v218, v159, v160, v161
    v_or3_b32 v217, v217, v162, v163
    v_or_b32 v217, v217, v218
    v_and_b32 v217, s37, v217
    v_cmp_ne_u32 vcc, 0, v217
    s_nop 0
    s_cbranch_vccnz K2_R27
K2_B27:
    v_mfma_f32_32x32x16_bf16 v[116:131], v[180:183], v[12:15], 0
    v_exp_f32 v132, v100
    v_exp_f32 v133, v101
    v_exp_f32 v134, v102
    v_exp_f32 v135, v103
    v_mfma_f32_32x32x16_bf16 v[116:131], v[184:187], v[16:19], v[116:131]
    v_exp_f32 v136, v104
    v_exp_f32 v137, v105
    v_exp_f32 v138, v106
    v_exp_f32 v139, v107
    v_mfma_f32_32x32x16_bf16 v[84:99], v[172:175], v[156:159], v[84:99]
    v_exp_f32 v140, v108
    v_exp_f32 v141, v109
    v_exp_f32 v142, v110
    v_exp_f32 v143, v111
    v_mfma_f32_32x32x16_bf16 v[84:99], v[176:179], v[160:163], v[84:99]
    v_exp_f32 v144, v112
    v_exp_f32 v145, v113
    v_exp_f32 v146, v114
    v_exp_f32 v147, v115
    v_cvt_pk_bf16_f32 v148, v132, v133
    v_cvt_pk_bf16_f32 v149, v134, v135
    v_cvt_pk_bf16_f32 v150, v136, v137
    v_cvt_pk_bf16_f32 v151, v138, v139
    v_cvt_pk_bf16_f32 v152, v140, v141
    v_cvt_pk_bf16_f32 v153, v142, v143
    v_cvt_pk_bf16_f32 v154, v144, v145
    v_cvt_pk_bf16_f32 v155, v146, v147
    v_or3_b32 v217, v148, v149, v150
    v_or3_b32 v218, v151, v152, v153
    v_or3_b32 v217, v217, v154, v155
    v_or_b32 v217, v217, v218
    v_and_b32 v217, s37, v217
    v_cmp_ne_u32 vcc, 0, v217
    s_nop 0
    s_cbranch_vccnz K2_R28
K2_B28:
    v_mfma_f32_32x32x16_bf16 v[100:115], v[180:183], v[20:23], 0
    v_exp_f32 v132, v116
    v_exp_f32 v133, v117
    v_exp_f32 v134, v118
    v_exp_f32 v135, v119
    v_mfma_f32_32x32x16_bf16 v[100:115], v[184:187], v[24:27], v[100:115]
    v_exp_f32 v136, v120
    v_exp_f32 v137, v121
    v_exp_f32 v138, v122
    v_exp_f32 v139, v123
    v_mfma_f32_32x32x16_bf16 v[36:51], v[188:191], v[148:151], v[36:51]
    v_exp_f32 v140, v124
    v_exp_f32 v141, v125
    v_exp_f32 v142, v126
    v_exp_f32 v143, v127
    v_mfma_f32_32x32x16_bf16 v[36:51], v[192:195], v[152:155], v[36:51]
    v_exp_f32 v144, v128
    v_exp_f32 v145, v129
    v_exp_f32 v146, v130
    v_exp_f32 v147, v131
    v_cvt_pk_bf16_f32 v156, v132, v133
    v_cvt_pk_bf16_f32 v157, v134, v135
    v_cvt_pk_bf16_f32 v158, v136, v137
    v_cvt_pk_bf16_f32 v159, v138, v139
    v_cvt_pk_bf16_f32 v160, v140, v141
    v_cvt_pk_bf16_f32 v161, v142, v143
    v_cvt_pk_bf16_f32 v162, v144, v145
    v_cvt_pk_bf16_f32 v163, v146, v147
    v_or3_b32 v217, v156, v157, v158
    v_or3_b32 v218, v159, v160, v161
    v_or3_b32 v217, v217, v162, v163
    v_or_b32 v217, v217, v218
    v_and_b32 v217, s37, v217
    v_cmp_ne_u32 vcc, 0, v217
    s_nop 0
    s_cbranch_vccnz K2_R29
K2_B29:
    v_mfma_f32_32x32x16_bf16 v[116:131], v[180:183], v[28:31], 0
    v_exp_f32 v132, v100
    v_exp_f32 v133, v101
    v_exp_f32 v134, v102
    v_exp_f32 v135, v103
    v_mfma_f32_32x32x16_bf16 v[116:131], v[184:187], v[32:35], v[116:131]
    v_exp_f32 v136, v104
    v_exp_f32 v137, v105
    v_exp_f32 v138, v106
    v_exp_f32 v139, v107
    v_mfma_f32_32x32x16_bf16 v[52:67], v[188:191], v[156:159], v[52:67]
    v_exp_f32 v140, v108
    v_exp_f32 v141, v109
    v_exp_f32 v142, v110
    v_exp_f32 v143, v111
    v_mfma_f32_32x32x16_bf16 v[52:67], v[192:195], v[160:163], v[52:67]
    v_exp_f32 v144, v112
    v_exp_f32 v145, v113
    v_exp_f32 v146, v114
    v_exp_f32 v147, v115
    v_cvt_pk_bf16_f32 v148, v132, v133
    v_cvt_pk_bf16_f32 v149, v134, v135
    v_cvt_pk_bf16_f32 v150, v136, v137
    v_cvt_pk_bf16_f32 v151, v138, v139
    v_cvt_pk_bf16_f32 v152, v140, v141
    v_cvt_pk_bf16_f32 v153, v142, v143
    v_cvt_pk_bf16_f32 v154, v144, v145
    v_cvt_pk_bf16_f32 v155, v146, v147
    v_or3_b32 v217, v148, v149, v150
    v_or3_b32 v218, v151, v152, v153
    v_or3_b32 v217, v217, v154, v155
    v_or_b32 v217, v217, v218
    v_and_b32 v217, s37, v217
    v_cmp_ne_u32 vcc, 0, v217
    s_nop 0
    s_cbranch_vccnz K2_R30
K2_B30:
    v_mfma_f32_32x32x16_bf16 v[68:83], v[188:191], v[148:151], v[68:83]
    v_exp_f32 v132, v116
    v_exp_f32 v133, v117
    v_exp_f32 v134, v118
    v_exp_f32 v135, v119
    v_mfma_f32_32x32x16_bf16 v[68:83], v[192:195], v[152:155], v[68:83]
    v_exp_f32 v136, v120
    v_exp_f32 v137, v121
    v_exp_f32 v138, v122
    v_exp_f32 v139, v123
    v_exp_f32 v140, v124
    v_exp_f32 v141, v125
    v_exp_f32 v142, v126
    v_exp_f32 v143, v127
    v_exp_f32 v144, v128
    v_exp_f32 v145, v129
    v_exp_f32 v146, v130
    v_exp_f32 v147, v131
    v_cvt_pk_bf16_f32 v156, v132, v133
    v_cvt_pk_bf16_f32 v157, v134, v135
    v_cvt_pk_bf16_f32 v158, v136, v137
    v_cvt_pk_bf16_f32 v159, v138, v139
    v_cvt_pk_bf16_f32 v160, v140, v141
    v_cvt_pk_bf16_f32 v161, v142, v143
    v_cvt_pk_bf16_f32 v162, v144, v145
    v_cvt_pk_bf16_f32 v163, v146, v147
    v_or3_b32 v217, v156, v157, v158
    v_or3_b32 v218, v159, v160, v161
    v_or3_b32 v217, v217, v162, v163
    v_or_b32 v217, v217, v218
    v_and_b32 v217, s37, v217
    v_cmp_ne_u32 vcc, 0, v217
    s_nop 0
    s_cbranch_vccnz K2_R31
K2_B31:
    v_mfma_f32_32x32x16_bf16 v[84:99], v[188:191], v[156:159], v[84:99]
    v_mfma_f32_32x32x16_bf16 v[84:99], v[192:195], v[160:163], v[84:99]
    s_branch K2_FIN
K2_R0:
    s_mov_b32 s41, 0
    s_branch K2_SL0
K2_R1:
    s_mov_b32 s41, 0
    s_branch K2_SL1
K2_R2:
    s_mov_b32 s41, 0
    s_branch K2_SL2
K2_R3:
    s_mov_b32 s41, 0
    s_branch K2_SL3
K2_R4:
    s_mov_b32 s41, 1
    s_branch K2_SL0
K2_R5:
    s_mov_b32 s41, 1
    s_branch K2_SL1
K2_R6:
    s_mov_b32 s41, 1
    s_branch K2_SL2
K2_R7:
    s_mov_b32 s41, 1
    s_branch K2_SL3
K2_R8:
    s_mov_b32 s41, 2
    s_branch K2_SL0
K2_R9:
    s_mov_b32 s41, 2
    s_branch K2_SL1
K2_R10:
    s_mov_b32 s41, 2
    s_branch K2_SL2
K2_R11:
    s_mov_b32 s41, 2
    s_branch K2_SL3
K2_R12:
    s_mov_b32 s41, 3
    s_branch K2_SL0
K2_R13:
    s_mov_b32 s41, 3
    s_branch K2_SL1
K2_R14:
    s_mov_b32 s41, 3
    s_branch K2_SL2
K2_R15:
    s_mov_b32 s41, 3
    s_branch K2_SL3
K2_R16:
    s_mov_b32 s41, 4
    s_branch K2_SL0
K2_R17:
    s_mov_b32 s41, 4
    s_branch K2_SL1
K2_R18:
    s_mov_b32 s41, 4
    s_branch K2_SL2
K2_R19:
    s_mov_b32 s41, 4
    s_branch K2_SL3
K2_R20:
    s_mov_b32 s41, 5
    s_branch K2_SL0
K2_R21:
    s_mov_b32 s41, 5
    s_branch K2_SL1
K2_R22:
    s_mov_b32 s41, 5
    s_branch K2_SL2
K2_R23:
    s_mov_b32 s41, 5
    s_branch K2_SL3
K2_R24:
    s_mov_b32 s41, 6
    s_branch K2_SL0
K2_R25:
    s_mov_b32 s41, 6
    s_branch K2_SL1
K2_R26:
    s_mov_b32 s41, 6
    s_branch K2_SL2
K2_R27:
    s_mov_b32 s41, 6
    s_branch K2_SL3
K2_R28:
    s_mov_b32 s41, 7
    s_branch K2_SL0
K2_R29:
    s_mov_b32 s41, 7
    s_branch K2_SL1
K2_R30:
    s_mov_b32 s41, 7
    s_branch K2_SL2
K2_R31:
    s_mov_b32 s41, 7
    s_branch K2_SL3
K2_SL0:
    s_cmp_eq_u32 s41, 0
    s_cselect_b32 s43, 0xff800000, 0
    v_max3_f32 v216, v100, v101, v102
    v_max3_f32 v216, v216, v103, v104
    v_max3_f32 v216, v216, v105, v106
    v_max3_f32 v216, v216, v107, v108
    v_max3_f32 v216, v216, v109, v110
    v_max3_f32 v216, v216, v111, v112
    v_max3_f32 v216, v216, v113, v114
    v_max_f32 v216, v216, v115
    v_mov_b32 v217, v216
    v_mov_b32 v218, v216
    s_nop 1
    v_permlane32_swap_b32 v217, v218
    s_nop 1
    v_max_f32 v217, v217, v218
    v_add_f32 v217, s36, v217
    v_max_f32 v217, s43, v217
    v_add_f32 v217, v212, v217
    v_cvt_pk_bf16_f32 v218, v217, v217
    v_lshlrev_b32 v217, 16, v218
    v_and_b32 v218, 0xffff, v218
    v_xor_b32 v218, 0x8000, v218
    v_cndmask_b32_e64 v10, v10, v218, s[32:33]
    v_sub_f32 v219, v217, v212
    v_mov_b32 v212, v217
    v_sub_f32 v132, v100, v219
    v_sub_f32 v133, v101, v219
    v_sub_f32 v134, v102, v219
    v_sub_f32 v135, v103, v219
    v_sub_f32 v136, v104, v219
    v_sub_f32 v137, v105, v219
    v_sub_f32 v138, v106, v219
    v_sub_f32 v139, v107, v219
    v_sub_f32 v140, v108, v219
    v_sub_f32 v141, v109, v219
    v_sub_f32 v142, v110, v219
    v_sub_f32 v143, v111, v219
    v_sub_f32 v144, v112, v219
    v_sub_f32 v145, v113, v219
    v_sub_f32 v146, v114, v219
    v_sub_f32 v147, v115, v219
    v_exp_f32 v132, v132
    v_exp_f32 v133, v133
    v_exp_f32 v134, v134
    v_exp_f32 v135, v135
    v_exp_f32 v136, v136
    v_exp_f32 v137, v137
    v_exp_f32 v138, v138
    v_exp_f32 v139, v139
    v_exp_f32 v140, v140
    v_exp_f32 v141, v141
    v_exp_f32 v142, v142
    v_exp_f32 v143, v143
    v_exp_f32 v144, v144
    v_exp_f32 v145, v145
    v_exp_f32 v146, v146
    v_exp_f32 v147, v147
    s_nop 0
    v_cvt_pk_bf16_f32 v148, v132, v133
    v_cvt_pk_bf16_f32 v149, v134, v135
    v_cvt_pk_bf16_f32 v150, v136, v137
    v_cvt_pk_bf16_f32 v151, v138, v139
    v_cvt_pk_bf16_f32 v152, v140, v141
    v_cvt_pk_bf16_f32 v153, v142, v143
    v_cvt_pk_bf16_f32 v154, v144, v145
    v_cvt_pk_bf16_f32 v155, v146, v147
    s_cbranch_scc1 K2_B0
    v_sub_f32 v219, 0, v219
    v_exp_f32 v219, v219
    s_nop 0
    v_mul_f32 v36, v36, v219
    v_mul_f32 v37, v37, v219
    v_mul_f32 v38, v38, v219
    v_mul_f32 v39, v39, v219
    v_mul_f32 v40, v40, v219
    v_mul_f32 v41, v41, v219
    v_mul_f32 v42, v42, v219
    v_mul_f32 v43, v43, v219
    v_mul_f32 v44, v44, v219
    v_mul_f32 v45, v45, v219
    v_mul_f32 v46, v46, v219
    v_mul_f32 v47, v47, v219
    v_mul_f32 v48, v48, v219
    v_mul_f32 v49, v49, v219
    v_mul_f32 v50, v50, v219
    v_mul_f32 v51, v51, v219
    s_cmp_eq_u32 s41, 1
    s_cbranch_scc1 K2_B4
    s_cmp_eq_u32 s41, 2
    s_cbranch_scc1 K2_B8
    s_cmp_eq_u32 s41, 3
    s_cbranch_scc1 K2_B12
    s_cmp_eq_u32 s41, 4
    s_cbranch_scc1 K2_B16
    s_cmp_eq_u32 s41, 5
    s_cbranch_scc1 K2_B20
    s_cmp_eq_u32 s41, 6
    s_cbranch_scc1 K2_B24
    s_cmp_eq_u32 s41, 7
    s_cbranch_scc1 K2_B28
    s_endpgm
K2_SL1:
    s_cmp_eq_u32 s41, 0
    s_cselect_b32 s43, 0xff800000, 0
    v_max3_f32 v216, v116, v117, v118
    v_max3_f32 v216, v216, v119, v120
    v_max3_f32 v216, v216, v121, v122
    v_max3_f32 v216, v216, v123, v124
    v_max3_f32 v216, v216, v125, v126
    v_max3_f32 v216, v216, v127, v128
    v_max3_f32 v216, v216, v129, v130
    v_max_f32 v216, v216, v131
    v_mov_b32 v217, v216
    v_mov_b32 v218, v216
    s_nop 1
    v_permlane32_swap_b32 v217, v218
    s_nop 1
    v_max_f32 v217, v217, v218
    v_add_f32 v217, s36, v217
    v_max_f32 v217, s43, v217
    v_add_f32 v217, v213, v217
    v_cvt_pk_bf16_f32 v218, v217, v217
    v_lshlrev_b32 v217, 16, v218
    v_and_b32 v218, 0xffff, v218
    v_xor_b32 v218, 0x8000, v218
    v_cndmask_b32_e64 v18, v18, v218, s[32:33]
    v_sub_f32 v219, v217, v213
    v_mov_b32 v213, v217
    v_sub_f32 v132, v116, v219
    v_sub_f32 v133, v117, v219
    v_sub_f32 v134, v118, v219
    v_sub_f32 v135, v119, v219
    v_sub_f32 v136, v120, v219
    v_sub_f32 v137, v121, v219
    v_sub_f32 v138, v122, v219
    v_sub_f32 v139, v123, v219
    v_sub_f32 v140, v124, v219
    v_sub_f32 v141, v125, v219
    v_sub_f32 v142, v126, v219
    v_sub_f32 v143, v127, v219
    v_sub_f32 v144, v128, v219
    v_sub_f32 v145, v129, v219
    v_sub_f32 v146, v130, v219
    v_sub_f32 v147, v131, v219
    v_exp_f32 v132, v132
    v_exp_f32 v133, v133
    v_exp_f32 v134, v134
    v_exp_f32 v135, v135
    v_exp_f32 v136, v136
    v_exp_f32 v137, v137
    v_exp_f32 v138, v138
    v_exp_f32 v139, v139
    v_exp_f32 v140, v140
    v_exp_f32 v141, v141
    v_exp_f32 v142, v142
    v_exp_f32 v143, v143
    v_exp_f32 v144, v144
    v_exp_f32 v145, v145
    v_exp_f32 v146, v146
    v_exp_f32 v147, v147
    s_nop 0
    v_cvt_pk_bf16_f32 v156, v132, v133
    v_cvt_pk_bf16_f32 v157, v134, v135
    v_cvt_pk_bf16_f32 v158, v136, v137
    v_cvt_pk_bf16_f32 v159, v138, v139
    v_cvt_pk_bf16_f32 v160, v140, v141
    v_cvt_pk_bf16_f32 v161, v142, v143
    v_cvt_pk_bf16_f32 v162, v144, v145
    v_cvt_pk_bf16_f32 v163, v146, v147
    s_cbranch_scc1 K2_B1
    v_sub_f32 v219, 0, v219
    v_exp_f32 v219, v219
    s_nop 0
    v_mul_f32 v52, v52, v219
    v_mul_f32 v53, v53, v219
    v_mul_f32 v54, v54, v219
    v_mul_f32 v55, v55, v219
    v_mul_f32 v56, v56, v219
    v_mul_f32 v57, v57, v219
    v_mul_f32 v58, v58, v219
    v_mul_f32 v59, v59, v219
    v_mul_f32 v60, v60, v219
    v_mul_f32 v61, v61, v219
    v_mul_f32 v62, v62, v219
    v_mul_f32 v63, v63, v219
    v_mul_f32 v64, v64, v219
    v_mul_f32 v65, v65, v219
    v_mul_f32 v66, v66, v219
    v_mul_f32 v67, v67, v219
    s_cmp_eq_u32 s41, 1
    s_cbranch_scc1 K2_B5
    s_cmp_eq_u32 s41, 2
    s_cbranch_scc1 K2_B9
    s_cmp_eq_u32 s41, 3
    s_cbranch_scc1 K2_B13
    s_cmp_eq_u32 s41, 4
    s_cbranch_scc1 K2_B17
    s_cmp_eq_u32 s41, 5
    s_cbranch_scc1 K2_B21
    s_cmp_eq_u32 s41, 6
    s_cbranch_scc1 K2_B25
    s_cmp_eq_u32 s41, 7
    s_cbranch_scc1 K2_B29
    s_endpgm
K2_SL2:
    s_cmp_eq_u32 s41, 0
    s_cselect_b32 s43, 0xff800000, 0
    v_max3_f32 v216, v100, v101, v102
    v_max3_f32 v216, v216, v103, v104
    v_max3_f32 v216, v216, v105, v106
    v_max3_f32 v216, v216, v107, v108
    v_max3_f32 v216, v216, v109, v110
    v_max3_f32 v216, v216, v111, v112
    v_max3_f32 v216, v216, v113, v114
    v_max_f32 v216, v216, v115
    v_mov_b32 v217, v216
    v_mov_b32 v218, v216
    s_nop 1
    v_permlane32_swap_b32 v217, v218
    s_nop 1
    v_max_f32 v217, v217, v218
    v_add_f32 v217, s36, v217
    v_max_f32 v217, s43, v217
    v_add_f32 v217, v214, v217
    v_cvt_pk_bf16_f32 v218, v217, v217
    v_lshlrev_b32 v217, 16, v218
    v_and_b32 v218, 0xffff, v218
    v_xor_b32 v218, 0x8000, v218
    v_cndmask_b32_e64 v26, v26, v218, s[32:33]
    v_sub_f32 v219, v217, v214
    v_mov_b32 v214, v217
    v_sub_f32 v132, v100, v219
    v_sub_f32 v133, v101, v219
    v_sub_f32 v134, v102, v219
    v_sub_f32 v135, v103, v219
    v_sub_f32 v136, v104, v219
    v_sub_f32 v137, v105, v219
    v_sub_f32 v138, v106, v219
    v_sub_f32 v139, v107, v219
    v_sub_f32 v140, v108, v219
    v_sub_f32 v141, v109, v219
    v_sub_f32 v142, v110, v219
    v_sub_f32 v143, v111, v219
    v_sub_f32 v144, v112, v219
    v_sub_f32 v145, v113, v219
    v_sub_f32 v146, v114, v219
    v_sub_f32 v147, v115, v219
    v_exp_f32 v132, v132
    v_exp_f32 v133, v133
    v_exp_f32 v134, v134
    v_exp_f32 v135, v135
    v_exp_f32 v136, v136
    v_exp_f32 v137, v137
    v_exp_f32 v138, v138
    v_exp_f32 v139, v139
    v_exp_f32 v140, v140
    v_exp_f32 v141, v141
    v_exp_f32 v142, v142
    v_exp_f32 v143, v143
    v_exp_f32 v144, v144
    v_exp_f32 v145, v145
    v_exp_f32 v146, v146
    v_exp_f32 v147, v147
    s_nop 0
    v_cvt_pk_bf16_f32 v148, v132, v133
    v_cvt_pk_bf16_f32 v149, v134, v135
    v_cvt_pk_bf16_f32 v150, v136, v137
    v_cvt_pk_bf16_f32 v151, v138, v139
    v_cvt_pk_bf16_f32 v152, v140, v141
    v_cvt_pk_bf16_f32 v153, v142, v143
    v_cvt_pk_bf16_f32 v154, v144, v145
    v_cvt_pk_bf16_f32 v155, v146, v147
    s_cbranch_scc1 K2_B2
    v_sub_f32 v219, 0, v219
    v_exp_f32 v219, v219
    s_nop 0
    v_mul_f32 v68, v68, v219
    v_mul_f32 v69, v69, v219
    v_mul_f32 v70, v70, v219
    v_mul_f32 v71, v71, v219
    v_mul_f32 v72, v72, v219
    v_mul_f32 v73, v73, v219
    v_mul_f32 v74, v74, v219
    v_mul_f32 v75, v75, v219
    v_mul_f32 v76, v76, v219
    v_mul_f32 v77, v77, v219
    v_mul_f32 v78, v78, v219
    v_mul_f32 v79, v79, v219
    v_mul_f32 v80, v80, v219
    v_mul_f32 v81, v81, v219
    v_mul_f32 v82, v82, v219
    v_mul_f32 v83, v83, v219
    s_cmp_eq_u32 s41, 1
    s_cbranch_scc1 K2_B6
    s_cmp_eq_u32 s41, 2
    s_cbranch_scc1 K2_B10
    s_cmp_eq_u32 s41, 3
    s_cbranch_scc1 K2_B14
    s_cmp_eq_u32 s41, 4
    s_cbranch_scc1 K2_B18
    s_cmp_eq_u32 s41, 5
    s_cbranch_scc1 K2_B22
    s_cmp_eq_u32 s41, 6
    s_cbranch_scc1 K2_B26
    s_cmp_eq_u32 s41, 7
    s_cbranch_scc1 K2_B30
    s_endpgm
K2_SL3:
    s_cmp_eq_u32 s41, 0
    s_cselect_b32 s43, 0xff800000, 0
    v_max3_f32 v216, v116, v117, v118
    v_max3_f32 v216, v216, v119, v120
    v_max3_f32 v216, v216, v121, v122
    v_max3_f32 v216, v216, v123, v124
    v_max3_f32 v216, v216, v125, v126
    v_max3_f32 v216, v216, v127, v128
    v_max3_f32 v216, v216, v129, v130
    v_max_f32 v216, v216, v131
    v_mov_b32 v217, v216
    v_mov_b32 v218, v216
    s_nop 1
    v_permlane32_swap_b32 v217, v218
    s_nop 1
    v_max_f32 v217, v217, v218
    v_add_f32 v217, s36, v217
    v_max_f32 v217, s43, v217
    v_add_f32 v217, v215, v217
    v_cvt_pk_bf16_f32 v218, v217, v217
    v_lshlrev_b32 v217, 16, v218
    v_and_b32 v218, 0xffff, v218
    v_xor_b32 v218, 0x8000, v218
    v_cndmask_b32_e64 v34, v34, v218, s[32:33]
    v_sub_f32 v219, v217, v215
    v_mov_b32 v215, v217
    v_sub_f32 v132, v116, v219
    v_sub_f32 v133, v117, v219
    v_sub_f32 v134, v118, v219
    v_sub_f32 v135, v119, v219
    v_sub_f32 v136, v120, v219
    v_sub_f32 v137, v121, v219
    v_sub_f32 v138, v122, v219
    v_sub_f32 v139, v123, v219
    v_sub_f32 v140, v124, v219
    v_sub_f32 v141, v125, v219
    v_sub_f32 v142, v126, v219
    v_sub_f32 v143, v127, v219
    v_sub_f32 v144, v128, v219
    v_sub_f32 v145, v129, v219
    v_sub_f32 v146, v130, v219
    v_sub_f32 v147, v131, v219
    v_exp_f32 v132, v132
    v_exp_f32 v133, v133
    v_exp_f32 v134, v134
    v_exp_f32 v135, v135
    v_exp_f32 v136, v136
    v_exp_f32 v137, v137
    v_exp_f32 v138, v138
    v_exp_f32 v139, v139
    v_exp_f32 v140, v140
    v_exp_f32 v141, v141
    v_exp_f32 v142, v142
    v_exp_f32 v143, v143
    v_exp_f32 v144, v144
    v_exp_f32 v145, v145
    v_exp_f32 v146, v146
    v_exp_f32 v147, v147
    s_nop 0
    v_cvt_pk_bf16_f32 v156, v132, v133
    v_cvt_pk_bf16_f32 v157, v134, v135
    v_cvt_pk_bf16_f32 v158, v136, v137
    v_cvt_pk_bf16_f32 v159, v138, v139
    v_cvt_pk_bf16_f32 v160, v140, v141
    v_cvt_pk_bf16_f32 v161, v142, v143
    v_cvt_pk_bf16_f32 v162, v144, v145
    v_cvt_pk_bf16_f32 v163, v146, v147
    s_cbranch_scc1 K2_B3
    v_sub_f32 v219, 0, v219
    v_exp_f32 v219, v219
    s_nop 0
    v_mul_f32 v84, v84, v219
    v_mul_f32 v85, v85, v219
    v_mul_f32 v86, v86, v219
    v_mul_f32 v87, v87, v219
    v_mul_f32 v88, v88, v219
    v_mul_f32 v89, v89, v219
    v_mul_f32 v90, v90, v219
    v_mul_f32 v91, v91, v219
    v_mul_f32 v92, v92, v219
    v_mul_f32 v93, v93, v219
    v_mul_f32 v94, v94, v219
    v_mul_f32 v95, v95, v219
    v_mul_f32 v96, v96, v219
    v_mul_f32 v97, v97, v219
    v_mul_f32 v98, v98, v219
    v_mul_f32 v99, v99, v219
    s_cmp_eq_u32 s41, 1
    s_cbranch_scc1 K2_B7
    s_cmp_eq_u32 s41, 2
    s_cbranch_scc1 K2_B11
    s_cmp_eq_u32 s41, 3
    s_cbranch_scc1 K2_B15
    s_cmp_eq_u32 s41, 4
    s_cbranch_scc1 K2_B19
    s_cmp_eq_u32 s41, 5
    s_cbranch_scc1 K2_B23
    s_cmp_eq_u32 s41, 6
    s_cbranch_scc1 K2_B27
    s_cmp_eq_u32 s41, 7
    s_cbranch_scc1 K2_B31
    s_endpgm
K2_FIN:
    s_nop 15
    s_nop 7
    s_lshl_b32 s31, s22, 12
    v_add_u32 v100, s31, v3
    v_add_u32 v101, 0x10000, v100
    ds_write_b128 v100, v[36:39] offset:0
    ds_write_b128 v100, v[40:43] offset:1024
    ds_write_b128 v100, v[44:47] offset:2048
    ds_write_b128 v100, v[48:51] offset:3072
    ds_write_b128 v100, v[52:55] offset:32768
    ds_write_b128 v100, v[56:59] offset:33792
    ds_write_b128 v100, v[60:63] offset:34816
    ds_write_b128 v100, v[64:67] offset:35840
    ds_write_b128 v101, v[68:71] offset:0
    ds_write_b128 v101, v[72:75] offset:1024
    ds_write_b128 v101, v[76:79] offset:2048
    ds_write_b128 v101, v[80:83] offset:3072
    ds_write_b128 v101, v[84:87] offset:32768
    ds_write_b128 v101, v[88:91] offset:33792
    ds_write_b128 v101, v[92:95] offset:34816
    ds_write_b128 v101, v[96:99] offset:35840
    s_lshl_b32 s31, s22, 9
    v_lshlrev_b32 v102, 3, v2
    v_add_u32 v102, s31, v102
    v_add_u32 v102, 0x20000, v102
    v_mov_b32 v105, v48
    v_mov_b32 v112, v48
    v_mov_b32 v107, v64
    v_mov_b32 v113, v64
    v_mov_b32 v109, v80
    v_mov_b32 v114, v80
    v_mov_b32 v111, v96
    v_mov_b32 v115, v96
    s_nop 1
    v_permlane32_swap_b32 v112, v105
    v_mov_b32 v104, v212
    v_permlane32_swap_b32 v113, v107
    v_mov_b32 v106, v213
    v_permlane32_swap_b32 v114, v109
    v_mov_b32 v108, v214
    v_permlane32_swap_b32 v115, v111
    v_mov_b32 v110, v215
    s_nop 1
    ds_write_b64 v102, v[104:105] offset:0
    ds_write_b64 v102, v[106:107] offset:4096
    ds_write_b64 v102, v[108:109] offset:8192
    ds_write_b64 v102, v[110:111] offset:12288
    s_waitcnt lgkmcnt(0)
    s_barrier
    s_lshr_b32 s23, s22, 1
    s_and_b32 s24, s22, 1
    s_lshl_b32 s31, s23, 12
    v_lshlrev_b32 v102, 3, v2
    v_add_u32 v102, s31, v102
    v_add_u32 v102, 0x20000, v102
    ds_read_b64 v[164:165], v102 offset:0
    ds_read_b64 v[166:167], v102 offset:512
    ds_read_b64 v[168:169], v102 offset:1024
    ds_read_b64 v[170:171], v102 offset:1536
    ds_read_b64 v[172:173], v102 offset:2048
    ds_read_b64 v[174:175], v102 offset:2560
    ds_read_b64 v[176:177], v102 offset:3072
    ds_read_b64 v[178:179], v102 offset:3584
    s_lshl_b32 s31, s23, 15
    s_lshl_b32 s30, s24, 11
    s_add_u32 s31, s31, s30
    v_add_u32 v103, s31, v3
    ds_read_b128 v[36:39], v103 offset:0
    ds_read_b128 v[40:43], v103 offset:1024
    ds_read_b128 v[44:47], v103 offset:4096
    ds_read_b128 v[48:51], v103 offset:5120
    ds_read_b128 v[52:55], v103 offset:8192
    ds_read_b128 v[56:59], v103 offset:9216
    ds_read_b128 v[60:63], v103 offset:12288
    ds_read_b128 v[64:67], v103 offset:13312
    ds_read_b128 v[68:71], v103 offset:16384
    ds_read_b128 v[72:75], v103 offset:17408
    ds_read_b128 v[76:79], v103 offset:20480
    ds_read_b128 v[80:83], v103 offset:21504
    ds_read_b128 v[84:87], v103 offset:24576
    ds_read_b128 v[88:91], v103 offset:25600
    ds_read_b128 v[92:95], v103 offset:28672
    ds_read_b128 v[96:99], v103 offset:29696
    s_waitcnt lgkmcnt(15)
    s_waitcnt lgkmcnt(15)
    v_max3_f32 v217, v164, v166, v168
    v_max3_f32 v218, v170, v172, v174
    v_max3_f32 v217, v217, v176, v178
    v_max_f32 v217, v217, v218
    v_sub_f32 v164, v164, v217
    v_sub_f32 v166, v166, v217
    v_sub_f32 v168, v168, v217
    v_sub_f32 v170, v170, v217
    v_sub_f32 v172, v172, v217
    v_sub_f32 v174, v174, v217
    v_sub_f32 v176, v176, v217
    v_sub_f32 v178, v178, v217
    v_exp_f32 v164, v164
    v_exp_f32 v166, v166
    v_exp_f32 v168, v168
    v_exp_f32 v170, v170
    v_exp_f32 v172, v172
    v_exp_f32 v174, v174
    v_exp_f32 v176, v176
    v_exp_f32 v178, v178
    s_nop 0
    v_mul_f32 v218, v164, v165
    v_fmac_f32 v218, v166, v167
    v_fmac_f32 v218, v168, v169
    v_fmac_f32 v218, v170, v171
    v_fmac_f32 v218, v172, v173
    v_fmac_f32 v218, v174, v175
    v_fmac_f32 v218, v176, v177
    v_fmac_f32 v218, v178, v179
    v_rcp_f32 v218, v218
    s_waitcnt lgkmcnt(0)
    v_mul_f32 v36, v36, v164
    v_mul_f32 v37, v37, v164
    v_mul_f32 v38, v38, v164
    v_mul_f32 v39, v39, v164
    v_mul_f32 v40, v40, v164
    v_mul_f32 v41, v41, v164
    v_mul_f32 v42, v42, v164
    v_mul_f32 v43, v43, v164
    v_fmac_f32 v36, v44, v166
    v_fmac_f32 v37, v45, v166
    v_fmac_f32 v38, v46, v166
    v_fmac_f32 v39, v47, v166
    v_fmac_f32 v40, v48, v166
    v_fmac_f32 v41, v49, v166
    v_fmac_f32 v42, v50, v166
    v_fmac_f32 v43, v51, v166
    v_fmac_f32 v36, v52, v168
    v_fmac_f32 v37, v53, v168
    v_fmac_f32 v38, v54, v168
    v_fmac_f32 v39, v55, v168
    v_fmac_f32 v40, v56, v168
    v_fmac_f32 v41, v57, v168
    v_fmac_f32 v42, v58, v168
    v_fmac_f32 v43, v59, v168
    v_fmac_f32 v36, v60, v170
    v_fmac_f32 v37, v61, v170
    v_fmac_f32 v38, v62, v170
    v_fmac_f32 v39, v63, v170
    v_fmac_f32 v40, v64, v170
    v_fmac_f32 v41, v65, v170
    v_fmac_f32 v42, v66, v170
    v_fmac_f32 v43, v67, v170
    v_fmac_f32 v36, v68, v172
    v_fmac_f32 v37, v69, v172
    v_fmac_f32 v38, v70, v172
    v_fmac_f32 v39, v71, v172
    v_fmac_f32 v40, v72, v172
    v_fmac_f32 v41, v73, v172
    v_fmac_f32 v42, v74, v172
    v_fmac_f32 v43, v75, v172
    v_fmac_f32 v36, v76, v174
    v_fmac_f32 v37, v77, v174
    v_fmac_f32 v38, v78, v174
    v_fmac_f32 v39, v79, v174
    v_fmac_f32 v40, v80, v174
    v_fmac_f32 v41, v81, v174
    v_fmac_f32 v42, v82, v174
    v_fmac_f32 v43, v83, v174
    v_fmac_f32 v36, v84, v176
    v_fmac_f32 v37, v85, v176
    v_fmac_f32 v38, v86, v176
    v_fmac_f32 v39, v87, v176
    v_fmac_f32 v40, v88, v176
    v_fmac_f32 v41, v89, v176
    v_fmac_f32 v42, v90, v176
    v_fmac_f32 v43, v91, v176
    v_fmac_f32 v36, v92, v178
    v_fmac_f32 v37, v93, v178
    v_fmac_f32 v38, v94, v178
    v_fmac_f32 v39, v95, v178
    v_fmac_f32 v40, v96, v178
    v_fmac_f32 v41, v97, v178
    v_fmac_f32 v42, v98, v178
    v_fmac_f32 v43, v99, v178
    v_mul_f32 v36, v36, v218
    v_mul_f32 v37, v37, v218
    v_mul_f32 v38, v38, v218
    v_mul_f32 v39, v39, v218
    v_mul_f32 v40, v40, v218
    v_mul_f32 v41, v41, v218
    v_mul_f32 v42, v42, v218
    v_mul_f32 v43, v43, v218
    v_cvt_pk_bf16_f32 v148, v36, v37
    v_cvt_pk_bf16_f32 v149, v38, v39
    v_cvt_pk_bf16_f32 v150, v40, v41
    v_cvt_pk_bf16_f32 v151, v42, v43
    s_cmp_eq_u32 s24, 0
    s_cselect_b32 s33, 0, -1
    v_cndmask_b32_e64 v150, v150, 0, s[32:33]
    v_cndmask_b32_e64 v151, v151, 0, s[32:33]
    s_lshl_b32 s25, s21, 2
    s_add_u32 s25, s25, s23
    s_lshl_b32 s25, s25, 4
    s_add_u32 s25, s25, s20
    s_lshl_b32 s25, s25, 1
    s_add_u32 s25, s25, s24
    s_lshl_b32 s25, s25, 10
    buffer_store_dwordx4 v[148:151], v3, s[16:19], s25 offen sc1
    s_waitcnt vmcnt(0)
K2_END:
    s_endpgm
.globl k3_wo_kernel
.p2align 8
.type k3_wo_kernel,@function
k3_wo_kernel:
    s_cmp_ge_u32 s2, 252
    s_cbranch_scc1 K3_END
    s_cmp_ge_u32 s2, 224
    s_cbranch_scc1 K3_CS
    s_cmp_ge_u32 s2, 8
    s_cbranch_scc1 K3_NOPF
    s_getpc_b64 s[92:93]
K3_PC:
    s_add_u32 s92, s92, k4_ffn1_kernel-K3_PC
    s_addc_u32 s93, s93, 0
    s_mov_b32 s94, k5_down_kernel-k4_ffn1_kernel
    s_mov_b32 s95, 0x00020000
    v_lshlrev_b32 v9, 7, v0
    buffer_load_dword v9, v9, s[92:95], 0 offen
K3_NOPF:
    s_load_dwordx2 s[4:5], s[0:1], 0
    s_load_dwordx2 s[6:7], s[0:1], 16
    s_load_dwordx2 s[8:9], s[0:1], 72
    s_and_b32 s24, s2, 7
    s_lshr_b32 s25, s2, 3
    s_mul_i32 s20, s25, 9363
    s_lshr_b32 s20, s20, 16
    s_mul_i32 s21, s20, 7
    s_sub_u32 s21, s25, s21
    s_lshl_b32 s24, s24, 2
    s_add_u32 s20, s20, s24
    v_lshrrev_b32 v1, 6, v0
    v_and_b32 v2, 63, v0
    s_nop 0
    v_readfirstlane_b32 s22, v1
    s_waitcnt lgkmcnt(0)
    s_mov_b32 s12, s4
    s_mov_b32 s13, s5
    s_mov_b32 s14, 0x1c0000
    s_mov_b32 s15, 0x00020000
    s_mov_b32 s16, s6
    s_mov_b32 s17, s7
    s_mov_b32 s18, 0x62000
    s_mov_b32 s19, 0x00020000
    s_add_u32 s64, s8, 0x600000
    s_addc_u32 s65, s9, 0
    s_mov_b32 s66, 0x200000
    s_mov_b32 s67, 0x00020000
    s_add_u32 s68, s8, 0x800000
    s_addc_u32 s69, s9, 0
    s_mov_b32 s70, 0x1c0000
    s_mov_b32 s71, 0x00020000
    s_add_u32 s72, s8, 0xa00000
    s_addc_u32 s73, s9, 0
    s_mov_b32 s74, 0x1c000
    s_mov_b32 s75, 0x00020000
    s_and_b32 s23, s22, 1
    s_lshr_b32 s24, s22, 1
    v_lshrrev_b32 v3, 3, v2
    v_mul_u32_u24 v3, 0x380, v3
    v_lshrrev_b32 v4, 4, v2
    v_and_b32 v4, 1, v4
    v_lshlrev_b32 v4, 2, v4
    v_and_b32 v5, 7, v2
    v_xor_b32 v4, v4, v5
    v_lshl_add_u32 v3, v4, 4, v3
    s_lshl_b32 s25, s21, 7
    v_add_u32 v3, s25, v3
    s_lshl_b32 s26, s22, 10
    s_mul_i32 s27, s22, 0x1c00
    s_add_u32 m0, s26, 0
    s_add_u32 s32, s27, 0
    buffer_load_dwordx4 v3, s[16:19], s32 offen lds
    s_add_u32 m0, s26, 4096
    s_add_u32 s32, s27, 28672
    buffer_load_dwordx4 v3, s[16:19], s32 offen lds
    s_add_u32 m0, s26, 8192
    s_add_u32 s32, s27, 57344
    buffer_load_dwordx4 v3, s[16:19], s32 offen lds
    s_add_u32 m0, s26, 12288
    s_add_u32 s32, s27, 86016
    buffer_load_dwordx4 v3, s[16:19], s32 offen lds
    s_add_u32 m0, s26, 16384
    s_add_u32 s32, s27, 114688
    buffer_load_dwordx4 v3, s[16:19], s32 offen lds
    s_add_u32 m0, s26, 20480
    s_add_u32 s32, s27, 143360
    buffer_load_dwordx4 v3, s[16:19], s32 offen lds
    s_add_u32 m0, s26, 24576
    s_add_u32 s32, s27, 172032
    buffer_load_dwordx4 v3, s[16:19], s32 offen lds
    s_add_u32 m0, s26, 28672
    s_add_u32 s32, s27, 200704
    buffer_load_dwordx4 v3, s[16:19], s32 offen lds
    s_add_u32 m0, s26, 32768
    s_add_u32 s32, s27, 229376
    buffer_load_dwordx4 v3, s[16:19], s32 offen lds
    s_add_u32 m0, s26, 36864
    s_add_u32 s32, s27, 258048
    buffer_load_dwordx4 v3, s[16:19], s32 offen lds
    s_add_u32 m0, s26, 40960
    s_add_u32 s32, s27, 286720
    buffer_load_dwordx4 v3, s[16:19], s32 offen lds
    s_add_u32 m0, s26, 45056
    s_add_u32 s32, s27, 315392
    buffer_load_dwordx4 v3, s[16:19], s32 offen lds
    s_add_u32 m0, s26, 49152
    s_add_u32 s32, s27, 344064
    buffer_load_dwordx4 v3, s[16:19], s32 offen lds
    s_add_u32 m0, s26, 53248
    s_add_u32 s32, s27, 372736
    buffer_load_dwordx4 v3, s[16:19], s32 offen lds
    s_cmp_lg_u32 s22, 0
    s_cbranch_scc1 K3_NOX
    s_mov_b32 m0, 57344
    s_mov_b32 s32, 401408
    buffer_load_dwordx4 v3, s[16:19], s32 offen lds
K3_NOX:
    v_lshlrev_b32 v4, 4, v2
    s_lshl_b32 s28, s20, 1
    s_add_u32 s28, s28, s23
    s_lshl_b32 s28, s28, 15
    s_lshl_b32 s30, s24, 14
    s_add_u32 s28, s28, s30
    buffer_load_dwordx4 v[64:67], v4, s[64:67], s28 offen offset:0
    buffer_load_dwordx4 v[68:71], v4, s[64:67], s28 offen offset:1024
    buffer_load_dwordx4 v[72:75], v4, s[64:67], s28 offen offset:2048
    buffer_load_dwordx4 v[76:79], v4, s[64:67], s28 offen offset:3072
    s_add_u32 s28, s28, 4096
    buffer_load_dwordx4 v[80:83], v4, s[64:67], s28 offen offset:0
    buffer_load_dwordx4 v[84:87], v4, s[64:67], s28 offen offset:1024
    buffer_load_dwordx4 v[88:91], v4, s[64:67], s28 offen offset:2048
    buffer_load_dwordx4 v[92:95], v4, s[64:67], s28 offen offset:3072
    s_add_u32 s28, s28, 4096
    buffer_load_dwordx4 v[96:99], v4, s[64:67], s28 offen offset:0
    buffer_load_dwordx4 v[100:103], v4, s[64:67], s28 offen offset:1024
    buffer_load_dwordx4 v[104:107], v4, s[64:67], s28 offen offset:2048
    buffer_load_dwordx4 v[108:111], v4, s[64:67], s28 offen offset:3072
    s_add_u32 s28, s28, 4096
    buffer_load_dwordx4 v[112:115], v4, s[64:67], s28 offen offset:0
    buffer_load_dwordx4 v[116:119], v4, s[64:67], s28 offen offset:1024
    buffer_load_dwordx4 v[120:123], v4, s[64:67], s28 offen offset:2048
    buffer_load_dwordx4 v[124:127], v4, s[64:67], s28 offen offset:3072
    v_lshrrev_b32 v7, 3, v2
    s_lshl_b32 s30, s22, 3
    v_add_u32 v7, s30, v7
    v_and_b32 v6, 7, v2
    v_mul_u32_u24 v5, 0x380, v7
    v_lshl_add_u32 v5, v6, 4, v5
    s_mul_i32 s29, s20, 0xe000
    s_lshl_b32 s30, s21, 7
    s_add_u32 s29, s29, s30
    s_add_u32 s33, s29, 0x7000
    buffer_load_dwordx4 v[40:43], v5, s[12:15], s29 offen
    buffer_load_dwordx4 v[44:47], v5, s[12:15], s33 offen
    v_lshrrev_b32 v10, 4, v2
    v_and_b32 v11, 1, v10
    v_lshrrev_b32 v12, 1, v10
    v_lshrrev_b32 v13, 2, v2
    v_and_b32 v13, 3, v13
    v_and_b32 v14, 3, v2
    v_lshlrev_b32 v15, 5, v11
    v_lshl_add_u32 v15, v14, 3, v15
    v_lshrrev_b32 v11, 1, v13
    v_lshlrev_b32 v11, 6, v11
    v_xor_b32 v15, v11, v15
    v_lshl_add_u32 v12, v12, 2, v13
    v_lshl_add_u32 v8, v12, 7, v15
    s_mul_i32 s31, s24, 28672
    v_add_u32 v8, s31, v8
    v_xor_b32 v160, 64, v8
    s_waitcnt vmcnt(18)
    s_barrier
    ds_read_b64_tr_b16 v[144:145], v8 offset:0
    ds_read_b64_tr_b16 v[146:147], v8 offset:1024
    ds_read_b64_tr_b16 v[148:149], v160 offset:0
    ds_read_b64_tr_b16 v[150:151], v160 offset:1024
    ds_read_b64_tr_b16 v[152:153], v8 offset:2048
    ds_read_b64_tr_b16 v[154:155], v8 offset:3072
    ds_read_b64_tr_b16 v[156:157], v160 offset:2048
    ds_read_b64_tr_b16 v[158:159], v160 offset:3072
    s_waitcnt vmcnt(17) lgkmcnt(4)
    v_mfma_f32_32x32x16_bf16 v[16:31], v[144:147], v[64:67], 0
    v_mfma_f32_32x32x16_bf16 v[128:143], v[148:151], v[64:67], 0
    ds_read_b64_tr_b16 v[144:145], v8 offset:3584
    ds_read_b64_tr_b16 v[146:147], v8 offset:4608
    ds_read_b64_tr_b16 v[148:149], v160 offset:3584
    ds_read_b64_tr_b16 v[150:151], v160 offset:4608
    s_waitcnt vmcnt(16) lgkmcnt(4)
    v_mfma_f32_32x32x16_bf16 v[16:31], v[152:155], v[68:71], v[16:31]
    v_mfma_f32_32x32x16_bf16 v[128:143], v[156:159], v[68:71], v[128:143]
    ds_read_b64_tr_b16 v[152:153], v8 offset:5632
    ds_read_b64_tr_b16 v[154:155], v8 offset:6656
    ds_read_b64_tr_b16 v[156:157], v160 offset:5632
    ds_read_b64_tr_b16 v[158:159], v160 offset:6656
    s_waitcnt vmcnt(15) lgkmcnt(4)
    v_mfma_f32_32x32x16_bf16 v[16:31], v[144:147], v[72:75], v[16:31]
    v_mfma_f32_32x32x16_bf16 v[128:143], v[148:151], v[72:75], v[128:143]
    ds_read_b64_tr_b16 v[144:145], v8 offset:7168
    ds_read_b64_tr_b16 v[146:147], v8 offset:8192
    ds_read_b64_tr_b16 v[148:149], v160 offset:7168
    ds_read_b64_tr_b16 v[150:151], v160 offset:8192
    s_waitcnt vmcnt(14) lgkmcnt(4)
    v_mfma_f32_32x32x16_bf16 v[16:31], v[152:155], v[76:79], v[16:31]
    v_mfma_f32_32x32x16_bf16 v[128:143], v[156:159], v[76:79], v[128:143]
    ds_read_b64_tr_b16 v[152:153], v8 offset:9216
    ds_read_b64_tr_b16 v[154:155], v8 offset:10240
    ds_read_b64_tr_b16 v[156:157], v160 offset:9216
    ds_read_b64_tr_b16 v[158:159], v160 offset:10240
    s_waitcnt vmcnt(13) lgkmcnt(4)
    v_mfma_f32_32x32x16_bf16 v[16:31], v[144:147], v[80:83], v[16:31]
    v_mfma_f32_32x32x16_bf16 v[128:143], v[148:151], v[80:83], v[128:143]
    ds_read_b64_tr_b16 v[144:145], v8 offset:10752
    ds_read_b64_tr_b16 v[146:147], v8 offset:11776
    ds_read_b64_tr_b16 v[148:149], v160 offset:10752
    ds_read_b64_tr_b16 v[150:151], v160 offset:11776
    s_waitcnt vmcnt(12) lgkmcnt(4)
    v_mfma_f32_32x32x16_bf16 v[16:31], v[152:155], v[84:87], v[16:31]
    v_mfma_f32_32x32x16_bf16 v[128:143], v[156:159], v[84:87], v[128:143]
    ds_read_b64_tr_b16 v[152:153], v8 offset:12800
    ds_read_b64_tr_b16 v[154:155], v8 offset:13824
    ds_read_b64_tr_b16 v[156:157], v160 offset:12800
    ds_read_b64_tr_b16 v[158:159], v160 offset:13824
    s_waitcnt vmcnt(11) lgkmcnt(4)
    v_mfma_f32_32x32x16_bf16 v[16:31], v[144:147], v[88:91], v[16:31]
    v_mfma_f32_32x32x16_bf16 v[128:143], v[148:151], v[88:91], v[128:143]
    ds_read_b64_tr_b16 v[144:145], v8 offset:14336
    ds_read_b64_tr_b16 v[146:147], v8 offset:15360
    ds_read_b64_tr_b16 v[148:149], v160 offset:14336
    ds_read_b64_tr_b16 v[150:151], v160 offset:15360
    s_waitcnt vmcnt(10) lgkmcnt(4)
    v_mfma_f32_32x32x16_bf16 v[16:31], v[152:155], v[92:95], v[16:31]
    v_mfma_f32_32x32x16_bf16 v[128:143], v[156:159], v[92:95], v[128:143]
    ds_read_b64_tr_b16 v[152:153], v8 offset:16384
    ds_read_b64_tr_b16 v[154:155], v8 offset:17408
    ds_read_b64_tr_b16 v[156:157], v160 offset:16384
    ds_read_b64_tr_b16 v[158:159], v160 offset:17408
    s_waitcnt vmcnt(9) lgkmcnt(4)
    v_mfma_f32_32x32x16_bf16 v[16:31], v[144:147], v[96:99], v[16:31]
    v_mfma_f32_32x32x16_bf16 v[128:143], v[148:151], v[96:99], v[128:143]
    ds_read_b64_tr_b16 v[144:145], v8 offset:17920
    ds_read_b64_tr_b16 v[146:147], v8 offset:18944
    ds_read_b64_tr_b16 v[148:149], v160 offset:17920
    ds_read_b64_tr_b16 v[150:151], v160 offset:18944
    s_waitcnt vmcnt(8) lgkmcnt(4)
    v_mfma_f32_32x32x16_bf16 v[16:31], v[152:155], v[100:103], v[16:31]
    v_mfma_f32_32x32x16_bf16 v[128:143], v[156:159], v[100:103], v[128:143]
    ds_read_b64_tr_b16 v[152:153], v8 offset:19968
    ds_read_b64_tr_b16 v[154:155], v8 offset:20992
    ds_read_b64_tr_b16 v[156:157], v160 offset:19968
    ds_read_b64_tr_b16 v[158:159], v160 offset:20992
    s_waitcnt vmcnt(7) lgkmcnt(4)
    v_mfma_f32_32x32x16_bf16 v[16:31], v[144:147], v[104:107], v[16:31]
    v_mfma_f32_32x32x16_bf16 v[128:143], v[148:151], v[104:107], v[128:143]
    ds_read_b64_tr_b16 v[144:145], v8 offset:21504
    ds_read_b64_tr_b16 v[146:147], v8 offset:22528
    ds_read_b64_tr_b16 v[148:149], v160 offset:21504
    ds_read_b64_tr_b16 v[150:151], v160 offset:22528
    s_waitcnt vmcnt(6) lgkmcnt(4)
    v_mfma_f32_32x32x16_bf16 v[16:31], v[152:155], v[108:111], v[16:31]
    v_mfma_f32_32x32x16_bf16 v[128:143], v[156:159], v[108:111], v[128:143]
    ds_read_b64_tr_b16 v[152:153], v8 offset:23552
    ds_read_b64_tr_b16 v[154:155], v8 offset:24576
    ds_read_b64_tr_b16 v[156:157], v160 offset:23552
    ds_read_b64_tr_b16 v[158:159], v160 offset:24576
    s_waitcnt vmcnt(5) lgkmcnt(4)
    v_mfma_f32_32x32x16_bf16 v[16:31], v[144:147], v[112:115], v[16:31]
    v_mfma_f32_32x32x16_bf16 v[128:143], v[148:151], v[112:115], v[128:143]
    ds_read_b64_tr_b16 v[144:145], v8 offset:25088
    ds_read_b64_tr_b16 v[146:147], v8 offset:26112
    ds_read_b64_tr_b16 v[148:149], v160 offset:25088
    ds_read_b64_tr_b16 v[150:151], v160 offset:26112
    s_waitcnt vmcnt(4) lgkmcnt(4)
    v_mfma_f32_32x32x16_bf16 v[16:31], v[152:155], v[116:119], v[16:31]
    v_mfma_f32_32x32x16_bf16 v[128:143], v[156:159], v[116:119], v[128:143]
    ds_read_b64_tr_b16 v[152:153], v8 offset:27136
    ds_read_b64_tr_b16 v[154:155], v8 offset:28160
    ds_read_b64_tr_b16 v[156:157], v160 offset:27136
    ds_read_b64_tr_b16 v[158:159], v160 offset:28160
    s_waitcnt vmcnt(3) lgkmcnt(4)
    v_mfma_f32_32x32x16_bf16 v[16:31], v[144:147], v[120:123], v[16:31]
    v_mfma_f32_32x32x16_bf16 v[128:143], v[148:151], v[120:123], v[128:143]
    s_waitcnt vmcnt(0) lgkmcnt(0)
    v_mfma_f32_32x32x16_bf16 v[16:31], v[152:155], v[124:127], v[16:31]
    v_mfma_f32_32x32x16_bf16 v[128:143], v[156:159], v[124:127], v[128:143]
    s_lshl_b32 s30, s23, 13
    s_lshl_b32 s31, s24, 14
    s_add_u32 s30, s30, s31
    s_add_u32 s30, s30, 58368
    v_lshlrev_b32 v10, 4, v2
    v_add_u32 v10, s30, v10
    v_xor_b32 v11, 32, v10
    v_xor_b32 v12, 64, v10
    v_xor_b32 v13, 96, v10
    v_xor_b32 v162, 128, v10
    v_xor_b32 v163, 128, v11
    v_xor_b32 v164, 128, v12
    v_xor_b32 v165, 128, v13
    v_lshlrev_b32 v14, 1, v6
    v_xor_b32 v14, v7, v14
    v_lshlrev_b32 v14, 4, v14
    v_lshl_add_u32 v14, v6, 10, v14
    v_add_u32 v14, 58368, v14
    s_nop 7
    ds_write_b128 v10, v[16:19] offset:0
    ds_write_b128 v11, v[20:23] offset:1024
    ds_write_b128 v12, v[24:27] offset:2048
    ds_write_b128 v13, v[28:31] offset:3072
    s_nop 7
    ds_write_b128 v162, v[128:131] offset:4096
    ds_write_b128 v163, v[132:135] offset:5120
    ds_write_b128 v164, v[136:139] offset:6144
    ds_write_b128 v165, v[140:143] offset:7168
    v_lshlrev_b32 v64, 16, v40
    v_and_b32 v65, 0xffff0000, v40
    v_lshlrev_b32 v66, 16, v41
    v_and_b32 v67, 0xffff0000, v41
    v_lshlrev_b32 v68, 16, v42
    v_and_b32 v69, 0xffff0000, v42
    v_lshlrev_b32 v70, 16, v43
    v_and_b32 v71, 0xffff0000, v43
    v_lshlrev_b32 v72, 16, v44
    v_and_b32 v73, 0xffff0000, v44
    v_lshlrev_b32 v74, 16, v45
    v_and_b32 v75, 0xffff0000, v45
    v_lshlrev_b32 v76, 16, v46
    v_and_b32 v77, 0xffff0000, v46
    v_lshlrev_b32 v78, 16, v47
    v_and_b32 v79, 0xffff0000, v47
    s_waitcnt lgkmcnt(0)
    s_barrier
    ds_read_b128 v[80:83], v14 offset:0
    ds_read_b128 v[128:131], v14 offset:16384
    ds_read_b128 v[84:87], v14 offset:512
    ds_read_b128 v[132:135], v14 offset:16896
    ds_read_b128 v[88:91], v14 offset:8192
    ds_read_b128 v[136:139], v14 offset:24576
    ds_read_b128 v[92:95], v14 offset:8704
    ds_read_b128 v[140:143], v14 offset:25088
    s_waitcnt lgkmcnt(4)
    v_add_f32 v64, v64, v80
    v_add_f32 v65, v65, v81
    v_add_f32 v66, v66, v82
    v_add_f32 v67, v67, v83
    v_add_f32 v68, v68, v84
    v_add_f32 v69, v69, v85
    v_add_f32 v70, v70, v86
    v_add_f32 v71, v71, v87
    v_add_f32 v64, v64, v128
    v_add_f32 v65, v65, v129
    v_add_f32 v66, v66, v130
    v_add_f32 v67, v67, v131
    v_add_f32 v68, v68, v132
    v_add_f32 v69, v69, v133
    v_add_f32 v70, v70, v134
    v_add_f32 v71, v71, v135
    v_cvt_pk_bf16_f32 v56, v64, v65
    v_cvt_pk_bf16_f32 v57, v66, v67
    v_cvt_pk_bf16_f32 v58, v68, v69
    v_cvt_pk_bf16_f32 v59, v70, v71
    buffer_store_dwordx4 v[56:59], v5, s[68:71], s29 offen sc1
    s_waitcnt lgkmcnt(0)
    v_add_f32 v72, v72, v88
    v_add_f32 v73, v73, v89
    v_add_f32 v74, v74, v90
    v_add_f32 v75, v75, v91
    v_add_f32 v76, v76, v92
    v_add_f32 v77, v77, v93
    v_add_f32 v78, v78, v94
    v_add_f32 v79, v79, v95
    v_add_f32 v72, v72, v136
    v_add_f32 v73, v73, v137
    v_add_f32 v74, v74, v138
    v_add_f32 v75, v75, v139
    v_add_f32 v76, v76, v140
    v_add_f32 v77, v77, v141
    v_add_f32 v78, v78, v142
    v_add_f32 v79, v79, v143
    v_cvt_pk_bf16_f32 v60, v72, v73
    v_cvt_pk_bf16_f32 v61, v74, v75
    v_cvt_pk_bf16_f32 v62, v76, v77
    v_cvt_pk_bf16_f32 v63, v78, v79
    buffer_store_dwordx4 v[60:63], v5, s[68:71], s33 offen sc1
    v_lshlrev_b32 v64, 16, v56
    v_and_b32 v65, 0xffff0000, v56
    v_lshlrev_b32 v66, 16, v57
    v_and_b32 v67, 0xffff0000, v57
    v_lshlrev_b32 v68, 16, v58
    v_and_b32 v69, 0xffff0000, v58
    v_lshlrev_b32 v70, 16, v59
    v_and_b32 v71, 0xffff0000, v59
    v_lshlrev_b32 v72, 16, v60
    v_and_b32 v73, 0xffff0000, v60
    v_lshlrev_b32 v74, 16, v61
    v_and_b32 v75, 0xffff0000, v61
    v_lshlrev_b32 v76, 16, v62
    v_and_b32 v77, 0xffff0000, v62
    v_lshlrev_b32 v78, 16, v63
    v_and_b32 v79, 0xffff0000, v63
    v_pk_add_f32 v[104:105], v[64:65], v[66:67]
    v_pk_add_f32 v[106:107], v[68:69], v[70:71]
    v_pk_add_f32 v[112:113], v[72:73], v[74:75]
    v_pk_add_f32 v[114:115], v[76:77], v[78:79]
    v_pk_add_f32 v[104:105], v[104:105], v[106:107]
    v_pk_add_f32 v[112:113], v[112:113], v[114:115]
    v_add_f32 v104, v104, v105
    v_add_f32 v112, v112, v113
    s_nop 1
    v_add_f32_dpp v104, v104, v104 quad_perm:[1,0,3,2] row_mask:0xf bank_mask:0xf
    v_add_f32_dpp v112, v112, v112 quad_perm:[1,0,3,2] row_mask:0xf bank_mask:0xf
    s_nop 1
    v_add_f32_dpp v104, v104, v104 quad_perm:[2,3,0,1] row_mask:0xf bank_mask:0xf
    v_add_f32_dpp v112, v112, v112 quad_perm:[2,3,0,1] row_mask:0xf bank_mask:0xf
    s_nop 1
    v_add_f32_dpp v104, v104, v104 row_half_mirror row_mask:0xf bank_mask:0xf
    v_add_f32_dpp v112, v112, v112 row_half_mirror row_mask:0xf bank_mask:0xf
    v_mul_f32 v96, 0xbc800000, v104
    v_mul_f32 v97, 0xbc800000, v104
    v_mul_f32 v100, 0xbc800000, v112
    v_mul_f32 v101, 0xbc800000, v112
    v_pk_add_f32 v[64:65], v[64:65], v[96:97]
    v_pk_add_f32 v[66:67], v[66:67], v[96:97]
    v_pk_add_f32 v[68:69], v[68:69], v[96:97]
    v_pk_add_f32 v[70:71], v[70:71], v[96:97]
    v_pk_add_f32 v[72:73], v[72:73], v[100:101]
    v_pk_add_f32 v[74:75], v[74:75], v[100:101]
    v_pk_add_f32 v[76:77], v[76:77], v[100:101]
    v_pk_add_f32 v[78:79], v[78:79], v[100:101]
    v_pk_mul_f32 v[104:105], v[64:65], v[64:65]
    v_pk_mul_f32 v[106:107], v[66:67], v[66:67]
    v_pk_mul_f32 v[112:113], v[72:73], v[72:73]
    v_pk_mul_f32 v[114:115], v[74:75], v[74:75]
    v_pk_fma_f32 v[104:105], v[68:69], v[68:69], v[104:105]
    v_pk_fma_f32 v[106:107], v[70:71], v[70:71], v[106:107]
    v_pk_fma_f32 v[112:113], v[76:77], v[76:77], v[112:113]
    v_pk_fma_f32 v[114:115], v[78:79], v[78:79], v[114:115]
    v_pk_add_f32 v[104:105], v[104:105], v[106:107]
    v_pk_add_f32 v[112:113], v[112:113], v[114:115]
    v_add_f32 v97, v104, v105
    v_add_f32 v101, v112, v113
    s_nop 1
    v_add_f32_dpp v97, v97, v97 quad_perm:[1,0,3,2] row_mask:0xf bank_mask:0xf
    v_add_f32_dpp v101, v101, v101 quad_perm:[1,0,3,2] row_mask:0xf bank_mask:0xf
    s_nop 1
    v_add_f32_dpp v97, v97, v97 quad_perm:[2,3,0,1] row_mask:0xf bank_mask:0xf
    v_add_f32_dpp v101, v101, v101 quad_perm:[2,3,0,1] row_mask:0xf bank_mask:0xf
    s_nop 1
    v_add_f32_dpp v97, v97, v97 row_half_mirror row_mask:0xf bank_mask:0xf
    v_add_f32_dpp v101, v101, v101 row_half_mirror row_mask:0xf bank_mask:0xf
    v_lshlrev_b32 v104, 3, v7
    s_lshl_b32 s34, s21, 11
    s_lshl_b32 s35, s20, 6
    s_add_u32 s34, s34, s35
    s_lshl_b32 s34, s34, 3
    v_cmp_eq_u32 vcc, 0, v6
    s_and_saveexec_b64 s[36:37], vcc
    buffer_store_dwordx2 v[96:97], v104, s[72:75], s34 offen sc1
    buffer_store_dwordx2 v[100:101], v104, s[72:75], s34 offen offset:256 sc1
    s_mov_b64 exec, s[36:37]
    s_waitcnt vmcnt(0)
    s_branch K3_END
K3_CS:
    s_load_dwordx2 s[4:5], s[0:1], 32
    s_load_dwordx2 s[6:7], s[0:1], 40
    s_load_dwordx2 s[8:9], s[0:1], 72
    s_sub_u32 s20, s2, 224
    s_lshl_b32 s23, s20, 9
    s_sub_u32 s21, s20, 14
    s_cmp_ge_u32 s20, 14
    s_cselect_b32 s21, s21, s20
    s_waitcnt lgkmcnt(0)
    s_cselect_b32 s16, s6, s4
    s_cselect_b32 s17, s7, s5
    s_mov_b32 s18, 0x188000
    s_mov_b32 s19, 0x00020000
    s_add_u32 s72, s8, 0xa20000
    s_addc_u32 s73, s9, 0
    s_mov_b32 s74, 0x3800
    s_mov_b32 s75, 0x00020000
    v_lshrrev_b32 v1, 4, v0
    v_and_b32 v2, 15, v0
    v_mul_u32_u24 v3, 0xe00, v1
    v_lshl_add_u32 v3, v2, 4, v3
    s_lshl_b32 s24, s21, 8
    buffer_load_dwordx4 v[16:19], v3, s[16:19], s24 offen
    s_add_u32 s24, s24, 0xe000
    buffer_load_dwordx4 v[20:23], v3, s[16:19], s24 offen
    s_add_u32 s24, s24, 0xe000
    buffer_load_dwordx4 v[24:27], v3, s[16:19], s24 offen
    s_add_u32 s24, s24, 0xe000
    buffer_load_dwordx4 v[28:31], v3, s[16:19], s24 offen
    s_add_u32 s24, s24, 0xe000
    buffer_load_dwordx4 v[32:35], v3, s[16:19], s24 offen
    s_add_u32 s24, s24, 0xe000
    buffer_load_dwordx4 v[36:39], v3, s[16:19], s24 offen
    s_add_u32 s24, s24, 0xe000
    buffer_load_dwordx4 v[40:43], v3, s[16:19], s24 offen
    s_add_u32 s24, s24, 0xe000
    buffer_load_dwordx4 v[44:47], v3, s[16:19], s24 offen
    s_add_u32 s24, s24, 0xe000
    buffer_load_dwordx4 v[48:51], v3, s[16:19], s24 offen
    s_add_u32 s24, s24, 0xe000
    buffer_load_dwordx4 v[52:55], v3, s[16:19], s24 offen
    s_add_u32 s24, s24, 0xe000
    buffer_load_dwordx4 v[56:59], v3, s[16:19], s24 offen
    s_add_u32 s24, s24, 0xe000
    buffer_load_dwordx4 v[60:63], v3, s[16:19], s24 offen
    s_add_u32 s24, s24, 0xe000
    buffer_load_dwordx4 v[64:67], v3, s[16:19], s24 offen
    s_add_u32 s24, s24, 0xe000
    buffer_load_dwordx4 v[68:71], v3, s[16:19], s24 offen
    s_add_u32 s24, s24, 0xe000
    buffer_load_dwordx4 v[72:75], v3, s[16:19], s24 offen
    s_add_u32 s24, s24, 0xe000
    buffer_load_dwordx4 v[76:79], v3, s[16:19], s24 offen
    s_add_u32 s24, s24, 0xe000
    buffer_load_dwordx4 v[80:83], v3, s[16:19], s24 offen
    s_add_u32 s24, s24, 0xe000
    buffer_load_dwordx4 v[84:87], v3, s[16:19], s24 offen
    s_add_u32 s24, s24, 0xe000
    buffer_load_dwordx4 v[88:91], v3, s[16:19], s24 offen
    s_add_u32 s24, s24, 0xe000
    buffer_load_dwordx4 v[92:95], v3, s[16:19], s24 offen
    s_add_u32 s24, s24, 0xe000
    buffer_load_dwordx4 v[96:99], v3, s[16:19], s24 offen
    s_add_u32 s24, s24, 0xe000
    buffer_load_dwordx4 v[100:103], v3, s[16:19], s24 offen
    s_add_u32 s24, s24, 0xe000
    buffer_load_dwordx4 v[104:107], v3, s[16:19], s24 offen
    s_add_u32 s24, s24, 0xe000
    buffer_load_dwordx4 v[108:111], v3, s[16:19], s24 offen
    s_add_u32 s24, s24, 0xe000
    buffer_load_dwordx4 v[112:115], v3, s[16:19], s24 offen
    s_add_u32 s24, s24, 0xe000
    buffer_load_dwordx4 v[116:119], v3, s[16:19], s24 offen
    s_add_u32 s24, s24, 0xe000
    buffer_load_dwordx4 v[120:123], v3, s[16:19], s24 offen
    s_add_u32 s24, s24, 0xe000
    buffer_load_dwordx4 v[124:127], v3, s[16:19], s24 offen
    s_add_u32 s24, s24, 0xe000
    v_mov_b32 v128, 0
    v_mov_b32 v129, 0
    v_mov_b32 v130, 0
    v_mov_b32 v131, 0
    v_mov_b32 v132, 0
    v_mov_b32 v133, 0
    v_mov_b32 v134, 0
    v_mov_b32 v135, 0
    s_waitcnt vmcnt(27)
    v_lshlrev_b32 v136, 16, v16
    v_and_b32 v137, 0xffff0000, v16
    v_lshlrev_b32 v138, 16, v17
    v_and_b32 v139, 0xffff0000, v17
    v_lshlrev_b32 v140, 16, v18
    v_and_b32 v141, 0xffff0000, v18
    v_lshlrev_b32 v142, 16, v19
    v_and_b32 v143, 0xffff0000, v19
    v_pk_add_f32 v[128:129], v[128:129], v[136:137]
    v_pk_add_f32 v[130:131], v[130:131], v[138:139]
    v_pk_add_f32 v[132:133], v[132:133], v[140:141]
    v_pk_add_f32 v[134:135], v[134:135], v[142:143]
    s_waitcnt vmcnt(26)
    v_lshlrev_b32 v144, 16, v20
    v_and_b32 v145, 0xffff0000, v20
    v_lshlrev_b32 v146, 16, v21
    v_and_b32 v147, 0xffff0000, v21
    v_lshlrev_b32 v148, 16, v22
    v_and_b32 v149, 0xffff0000, v22
    v_lshlrev_b32 v150, 16, v23
    v_and_b32 v151, 0xffff0000, v23
    v_pk_add_f32 v[128:129], v[128:129], v[144:145]
    v_pk_add_f32 v[130:131], v[130:131], v[146:147]
    v_pk_add_f32 v[132:133], v[132:133], v[148:149]
    v_pk_add_f32 v[134:135], v[134:135], v[150:151]
    s_waitcnt vmcnt(25)
    v_lshlrev_b32 v136, 16, v24
    v_and_b32 v137, 0xffff0000, v24
    v_lshlrev_b32 v138, 16, v25
    v_and_b32 v139, 0xffff0000, v25
    v_lshlrev_b32 v140, 16, v26
    v_and_b32 v141, 0xffff0000, v26
    v_lshlrev_b32 v142, 16, v27
    v_and_b32 v143, 0xffff0000, v27
    v_pk_add_f32 v[128:129], v[128:129], v[136:137]
    v_pk_add_f32 v[130:131], v[130:131], v[138:139]
    v_pk_add_f32 v[132:133], v[132:133], v[140:141]
    v_pk_add_f32 v[134:135], v[134:135], v[142:143]
    s_waitcnt vmcnt(24)
    v_lshlrev_b32 v144, 16, v28
    v_and_b32 v145, 0xffff0000, v28
    v_lshlrev_b32 v146, 16, v29
    v_and_b32 v147, 0xffff0000, v29
    v_lshlrev_b32 v148, 16, v30
    v_and_b32 v149, 0xffff0000, v30
    v_lshlrev_b32 v150, 16, v31
    v_and_b32 v151, 0xffff0000, v31
    v_pk_add_f32 v[128:129], v[128:129], v[144:145]
    v_pk_add_f32 v[130:131], v[130:131], v[146:147]
    v_pk_add_f32 v[132:133], v[132:133], v[148:149]
    v_pk_add_f32 v[134:135], v[134:135], v[150:151]
    s_waitcnt vmcnt(23)
    v_lshlrev_b32 v136, 16, v32
    v_and_b32 v137, 0xffff0000, v32
    v_lshlrev_b32 v138, 16, v33
    v_and_b32 v139, 0xffff0000, v33
    v_lshlrev_b32 v140, 16, v34
    v_and_b32 v141, 0xffff0000, v34
    v_lshlrev_b32 v142, 16, v35
    v_and_b32 v143, 0xffff0000, v35
    v_pk_add_f32 v[128:129], v[128:129], v[136:137]
    v_pk_add_f32 v[130:131], v[130:131], v[138:139]
    v_pk_add_f32 v[132:133], v[132:133], v[140:141]
    v_pk_add_f32 v[134:135], v[134:135], v[142:143]
    s_waitcnt vmcnt(22)
    v_lshlrev_b32 v144, 16, v36
    v_and_b32 v145, 0xffff0000, v36
    v_lshlrev_b32 v146, 16, v37
    v_and_b32 v147, 0xffff0000, v37
    v_lshlrev_b32 v148, 16, v38
    v_and_b32 v149, 0xffff0000, v38
    v_lshlrev_b32 v150, 16, v39
    v_and_b32 v151, 0xffff0000, v39
    v_pk_add_f32 v[128:129], v[128:129], v[144:145]
    v_pk_add_f32 v[130:131], v[130:131], v[146:147]
    v_pk_add_f32 v[132:133], v[132:133], v[148:149]
    v_pk_add_f32 v[134:135], v[134:135], v[150:151]
    s_waitcnt vmcnt(21)
    v_lshlrev_b32 v136, 16, v40
    v_and_b32 v137, 0xffff0000, v40
    v_lshlrev_b32 v138, 16, v41
    v_and_b32 v139, 0xffff0000, v41
    v_lshlrev_b32 v140, 16, v42
    v_and_b32 v141, 0xffff0000, v42
    v_lshlrev_b32 v142, 16, v43
    v_and_b32 v143, 0xffff0000, v43
    v_pk_add_f32 v[128:129], v[128:129], v[136:137]
    v_pk_add_f32 v[130:131], v[130:131], v[138:139]
    v_pk_add_f32 v[132:133], v[132:133], v[140:141]
    v_pk_add_f32 v[134:135], v[134:135], v[142:143]
    s_waitcnt vmcnt(20)
    v_lshlrev_b32 v144, 16, v44
    v_and_b32 v145, 0xffff0000, v44
    v_lshlrev_b32 v146, 16, v45
    v_and_b32 v147, 0xffff0000, v45
    v_lshlrev_b32 v148, 16, v46
    v_and_b32 v149, 0xffff0000, v46
    v_lshlrev_b32 v150, 16, v47
    v_and_b32 v151, 0xffff0000, v47
    v_pk_add_f32 v[128:129], v[128:129], v[144:145]
    v_pk_add_f32 v[130:131], v[130:131], v[146:147]
    v_pk_add_f32 v[132:133], v[132:133], v[148:149]
    v_pk_add_f32 v[134:135], v[134:135], v[150:151]
    s_waitcnt vmcnt(19)
    v_lshlrev_b32 v136, 16, v48
    v_and_b32 v137, 0xffff0000, v48
    v_lshlrev_b32 v138, 16, v49
    v_and_b32 v139, 0xffff0000, v49
    v_lshlrev_b32 v140, 16, v50
    v_and_b32 v141, 0xffff0000, v50
    v_lshlrev_b32 v142, 16, v51
    v_and_b32 v143, 0xffff0000, v51
    v_pk_add_f32 v[128:129], v[128:129], v[136:137]
    v_pk_add_f32 v[130:131], v[130:131], v[138:139]
    v_pk_add_f32 v[132:133], v[132:133], v[140:141]
    v_pk_add_f32 v[134:135], v[134:135], v[142:143]
    s_waitcnt vmcnt(18)
    v_lshlrev_b32 v144, 16, v52
    v_and_b32 v145, 0xffff0000, v52
    v_lshlrev_b32 v146, 16, v53
    v_and_b32 v147, 0xffff0000, v53
    v_lshlrev_b32 v148, 16, v54
    v_and_b32 v149, 0xffff0000, v54
    v_lshlrev_b32 v150, 16, v55
    v_and_b32 v151, 0xffff0000, v55
    v_pk_add_f32 v[128:129], v[128:129], v[144:145]
    v_pk_add_f32 v[130:131], v[130:131], v[146:147]
    v_pk_add_f32 v[132:133], v[132:133], v[148:149]
    v_pk_add_f32 v[134:135], v[134:135], v[150:151]
    s_waitcnt vmcnt(17)
    v_lshlrev_b32 v136, 16, v56
    v_and_b32 v137, 0xffff0000, v56
    v_lshlrev_b32 v138, 16, v57
    v_and_b32 v139, 0xffff0000, v57
    v_lshlrev_b32 v140, 16, v58
    v_and_b32 v141, 0xffff0000, v58
    v_lshlrev_b32 v142, 16, v59
    v_and_b32 v143, 0xffff0000, v59
    v_pk_add_f32 v[128:129], v[128:129], v[136:137]
    v_pk_add_f32 v[130:131], v[130:131], v[138:139]
    v_pk_add_f32 v[132:133], v[132:133], v[140:141]
    v_pk_add_f32 v[134:135], v[134:135], v[142:143]
    s_waitcnt vmcnt(16)
    v_lshlrev_b32 v144, 16, v60
    v_and_b32 v145, 0xffff0000, v60
    v_lshlrev_b32 v146, 16, v61
    v_and_b32 v147, 0xffff0000, v61
    v_lshlrev_b32 v148, 16, v62
    v_and_b32 v149, 0xffff0000, v62
    v_lshlrev_b32 v150, 16, v63
    v_and_b32 v151, 0xffff0000, v63
    v_pk_add_f32 v[128:129], v[128:129], v[144:145]
    v_pk_add_f32 v[130:131], v[130:131], v[146:147]
    v_pk_add_f32 v[132:133], v[132:133], v[148:149]
    v_pk_add_f32 v[134:135], v[134:135], v[150:151]
    s_waitcnt vmcnt(15)
    v_lshlrev_b32 v136, 16, v64
    v_and_b32 v137, 0xffff0000, v64
    v_lshlrev_b32 v138, 16, v65
    v_and_b32 v139, 0xffff0000, v65
    v_lshlrev_b32 v140, 16, v66
    v_and_b32 v141, 0xffff0000, v66
    v_lshlrev_b32 v142, 16, v67
    v_and_b32 v143, 0xffff0000, v67
    v_pk_add_f32 v[128:129], v[128:129], v[136:137]
    v_pk_add_f32 v[130:131], v[130:131], v[138:139]
    v_pk_add_f32 v[132:133], v[132:133], v[140:141]
    v_pk_add_f32 v[134:135], v[134:135], v[142:143]
    s_waitcnt vmcnt(14)
    v_lshlrev_b32 v144, 16, v68
    v_and_b32 v145, 0xffff0000, v68
    v_lshlrev_b32 v146, 16, v69
    v_and_b32 v147, 0xffff0000, v69
    v_lshlrev_b32 v148, 16, v70
    v_and_b32 v149, 0xffff0000, v70
    v_lshlrev_b32 v150, 16, v71
    v_and_b32 v151, 0xffff0000, v71
    v_pk_add_f32 v[128:129], v[128:129], v[144:145]
    v_pk_add_f32 v[130:131], v[130:131], v[146:147]
    v_pk_add_f32 v[132:133], v[132:133], v[148:149]
    v_pk_add_f32 v[134:135], v[134:135], v[150:151]
    s_waitcnt vmcnt(13)
    v_lshlrev_b32 v136, 16, v72
    v_and_b32 v137, 0xffff0000, v72
    v_lshlrev_b32 v138, 16, v73
    v_and_b32 v139, 0xffff0000, v73
    v_lshlrev_b32 v140, 16, v74
    v_and_b32 v141, 0xffff0000, v74
    v_lshlrev_b32 v142, 16, v75
    v_and_b32 v143, 0xffff0000, v75
    v_pk_add_f32 v[128:129], v[128:129], v[136:137]
    v_pk_add_f32 v[130:131], v[130:131], v[138:139]
    v_pk_add_f32 v[132:133], v[132:133], v[140:141]
    v_pk_add_f32 v[134:135], v[134:135], v[142:143]
    s_waitcnt vmcnt(12)
    v_lshlrev_b32 v144, 16, v76
    v_and_b32 v145, 0xffff0000, v76
    v_lshlrev_b32 v146, 16, v77
    v_and_b32 v147, 0xffff0000, v77
    v_lshlrev_b32 v148, 16, v78
    v_and_b32 v149, 0xffff0000, v78
    v_lshlrev_b32 v150, 16, v79
    v_and_b32 v151, 0xffff0000, v79
    v_pk_add_f32 v[128:129], v[128:129], v[144:145]
    v_pk_add_f32 v[130:131], v[130:131], v[146:147]
    v_pk_add_f32 v[132:133], v[132:133], v[148:149]
    v_pk_add_f32 v[134:135], v[134:135], v[150:151]
    s_waitcnt vmcnt(11)
    v_lshlrev_b32 v136, 16, v80
    v_and_b32 v137, 0xffff0000, v80
    v_lshlrev_b32 v138, 16, v81
    v_and_b32 v139, 0xffff0000, v81
    v_lshlrev_b32 v140, 16, v82
    v_and_b32 v141, 0xffff0000, v82
    v_lshlrev_b32 v142, 16, v83
    v_and_b32 v143, 0xffff0000, v83
    v_pk_add_f32 v[128:129], v[128:129], v[136:137]
    v_pk_add_f32 v[130:131], v[130:131], v[138:139]
    v_pk_add_f32 v[132:133], v[132:133], v[140:141]
    v_pk_add_f32 v[134:135], v[134:135], v[142:143]
    s_waitcnt vmcnt(10)
    v_lshlrev_b32 v144, 16, v84
    v_and_b32 v145, 0xffff0000, v84
    v_lshlrev_b32 v146, 16, v85
    v_and_b32 v147, 0xffff0000, v85
    v_lshlrev_b32 v148, 16, v86
    v_and_b32 v149, 0xffff0000, v86
    v_lshlrev_b32 v150, 16, v87
    v_and_b32 v151, 0xffff0000, v87
    v_pk_add_f32 v[128:129], v[128:129], v[144:145]
    v_pk_add_f32 v[130:131], v[130:131], v[146:147]
    v_pk_add_f32 v[132:133], v[132:133], v[148:149]
    v_pk_add_f32 v[134:135], v[134:135], v[150:151]
    s_waitcnt vmcnt(9)
    v_lshlrev_b32 v136, 16, v88
    v_and_b32 v137, 0xffff0000, v88
    v_lshlrev_b32 v138, 16, v89
    v_and_b32 v139, 0xffff0000, v89
    v_lshlrev_b32 v140, 16, v90
    v_and_b32 v141, 0xffff0000, v90
    v_lshlrev_b32 v142, 16, v91
    v_and_b32 v143, 0xffff0000, v91
    v_pk_add_f32 v[128:129], v[128:129], v[136:137]
    v_pk_add_f32 v[130:131], v[130:131], v[138:139]
    v_pk_add_f32 v[132:133], v[132:133], v[140:141]
    v_pk_add_f32 v[134:135], v[134:135], v[142:143]
    s_waitcnt vmcnt(8)
    v_lshlrev_b32 v144, 16, v92
    v_and_b32 v145, 0xffff0000, v92
    v_lshlrev_b32 v146, 16, v93
    v_and_b32 v147, 0xffff0000, v93
    v_lshlrev_b32 v148, 16, v94
    v_and_b32 v149, 0xffff0000, v94
    v_lshlrev_b32 v150, 16, v95
    v_and_b32 v151, 0xffff0000, v95
    v_pk_add_f32 v[128:129], v[128:129], v[144:145]
    v_pk_add_f32 v[130:131], v[130:131], v[146:147]
    v_pk_add_f32 v[132:133], v[132:133], v[148:149]
    v_pk_add_f32 v[134:135], v[134:135], v[150:151]
    s_waitcnt vmcnt(7)
    v_lshlrev_b32 v136, 16, v96
    v_and_b32 v137, 0xffff0000, v96
    v_lshlrev_b32 v138, 16, v97
    v_and_b32 v139, 0xffff0000, v97
    v_lshlrev_b32 v140, 16, v98
    v_and_b32 v141, 0xffff0000, v98
    v_lshlrev_b32 v142, 16, v99
    v_and_b32 v143, 0xffff0000, v99
    v_pk_add_f32 v[128:129], v[128:129], v[136:137]
    v_pk_add_f32 v[130:131], v[130:131], v[138:139]
    v_pk_add_f32 v[132:133], v[132:133], v[140:141]
    v_pk_add_f32 v[134:135], v[134:135], v[142:143]
    s_waitcnt vmcnt(6)
    v_lshlrev_b32 v144, 16, v100
    v_and_b32 v145, 0xffff0000, v100
    v_lshlrev_b32 v146, 16, v101
    v_and_b32 v147, 0xffff0000, v101
    v_lshlrev_b32 v148, 16, v102
    v_and_b32 v149, 0xffff0000, v102
    v_lshlrev_b32 v150, 16, v103
    v_and_b32 v151, 0xffff0000, v103
    v_pk_add_f32 v[128:129], v[128:129], v[144:145]
    v_pk_add_f32 v[130:131], v[130:131], v[146:147]
    v_pk_add_f32 v[132:133], v[132:133], v[148:149]
    v_pk_add_f32 v[134:135], v[134:135], v[150:151]
    s_waitcnt vmcnt(5)
    v_lshlrev_b32 v136, 16, v104
    v_and_b32 v137, 0xffff0000, v104
    v_lshlrev_b32 v138, 16, v105
    v_and_b32 v139, 0xffff0000, v105
    v_lshlrev_b32 v140, 16, v106
    v_and_b32 v141, 0xffff0000, v106
    v_lshlrev_b32 v142, 16, v107
    v_and_b32 v143, 0xffff0000, v107
    v_pk_add_f32 v[128:129], v[128:129], v[136:137]
    v_pk_add_f32 v[130:131], v[130:131], v[138:139]
    v_pk_add_f32 v[132:133], v[132:133], v[140:141]
    v_pk_add_f32 v[134:135], v[134:135], v[142:143]
    s_waitcnt vmcnt(4)
    v_lshlrev_b32 v144, 16, v108
    v_and_b32 v145, 0xffff0000, v108
    v_lshlrev_b32 v146, 16, v109
    v_and_b32 v147, 0xffff0000, v109
    v_lshlrev_b32 v148, 16, v110
    v_and_b32 v149, 0xffff0000, v110
    v_lshlrev_b32 v150, 16, v111
    v_and_b32 v151, 0xffff0000, v111
    v_pk_add_f32 v[128:129], v[128:129], v[144:145]
    v_pk_add_f32 v[130:131], v[130:131], v[146:147]
    v_pk_add_f32 v[132:133], v[132:133], v[148:149]
    v_pk_add_f32 v[134:135], v[134:135], v[150:151]
    s_waitcnt vmcnt(3)
    v_lshlrev_b32 v136, 16, v112
    v_and_b32 v137, 0xffff0000, v112
    v_lshlrev_b32 v138, 16, v113
    v_and_b32 v139, 0xffff0000, v113
    v_lshlrev_b32 v140, 16, v114
    v_and_b32 v141, 0xffff0000, v114
    v_lshlrev_b32 v142, 16, v115
    v_and_b32 v143, 0xffff0000, v115
    v_pk_add_f32 v[128:129], v[128:129], v[136:137]
    v_pk_add_f32 v[130:131], v[130:131], v[138:139]
    v_pk_add_f32 v[132:133], v[132:133], v[140:141]
    v_pk_add_f32 v[134:135], v[134:135], v[142:143]
    s_waitcnt vmcnt(2)
    v_lshlrev_b32 v144, 16, v116
    v_and_b32 v145, 0xffff0000, v116
    v_lshlrev_b32 v146, 16, v117
    v_and_b32 v147, 0xffff0000, v117
    v_lshlrev_b32 v148, 16, v118
    v_and_b32 v149, 0xffff0000, v118
    v_lshlrev_b32 v150, 16, v119
    v_and_b32 v151, 0xffff0000, v119
    v_pk_add_f32 v[128:129], v[128:129], v[144:145]
    v_pk_add_f32 v[130:131], v[130:131], v[146:147]
    v_pk_add_f32 v[132:133], v[132:133], v[148:149]
    v_pk_add_f32 v[134:135], v[134:135], v[150:151]
    s_waitcnt vmcnt(1)
    v_lshlrev_b32 v136, 16, v120
    v_and_b32 v137, 0xffff0000, v120
    v_lshlrev_b32 v138, 16, v121
    v_and_b32 v139, 0xffff0000, v121
    v_lshlrev_b32 v140, 16, v122
    v_and_b32 v141, 0xffff0000, v122
    v_lshlrev_b32 v142, 16, v123
    v_and_b32 v143, 0xffff0000, v123
    v_pk_add_f32 v[128:129], v[128:129], v[136:137]
    v_pk_add_f32 v[130:131], v[130:131], v[138:139]
    v_pk_add_f32 v[132:133], v[132:133], v[140:141]
    v_pk_add_f32 v[134:135], v[134:135], v[142:143]
    s_waitcnt vmcnt(0)
    v_lshlrev_b32 v144, 16, v124
    v_and_b32 v145, 0xffff0000, v124
    v_lshlrev_b32 v146, 16, v125
    v_and_b32 v147, 0xffff0000, v125
    v_lshlrev_b32 v148, 16, v126
    v_and_b32 v149, 0xffff0000, v126
    v_lshlrev_b32 v150, 16, v127
    v_and_b32 v151, 0xffff0000, v127
    v_pk_add_f32 v[128:129], v[128:129], v[144:145]
    v_pk_add_f32 v[130:131], v[130:131], v[146:147]
    v_pk_add_f32 v[132:133], v[132:133], v[148:149]
    v_pk_add_f32 v[134:135], v[134:135], v[150:151]
    v_lshlrev_b32 v4, 9, v1
    v_lshl_add_u32 v4, v2, 5, v4
    ds_write_b128 v4, v[128:131]
    ds_write_b128 v4, v[132:135] offset:16
    v_lshlrev_b32 v5, 2, v0
    s_waitcnt lgkmcnt(0)
    s_barrier
    v_cmp_gt_u32 vcc, 128, v0
    s_and_saveexec_b64 s[36:37], vcc
    s_cbranch_execz K3_END
    ds_read_b32 v16, v5 offset:0
    ds_read_b32 v17, v5 offset:512
    ds_read_b32 v18, v5 offset:1024
    ds_read_b32 v19, v5 offset:1536
    ds_read_b32 v20, v5 offset:2048
    ds_read_b32 v21, v5 offset:2560
    ds_read_b32 v22, v5 offset:3072
    ds_read_b32 v23, v5 offset:3584
    ds_read_b32 v24, v5 offset:4096
    ds_read_b32 v25, v5 offset:4608
    ds_read_b32 v26, v5 offset:5120
    ds_read_b32 v27, v5 offset:5632
    ds_read_b32 v28, v5 offset:6144
    ds_read_b32 v29, v5 offset:6656
    ds_read_b32 v30, v5 offset:7168
    ds_read_b32 v31, v5 offset:7680
    s_waitcnt lgkmcnt(0)
    v_add_f32 v16, v16, v24
    v_add_f32 v17, v17, v25
    v_add_f32 v18, v18, v26
    v_add_f32 v19, v19, v27
    v_add_f32 v20, v20, v28
    v_add_f32 v21, v21, v29
    v_add_f32 v22, v22, v30
    v_add_f32 v23, v23, v31
    v_add_f32 v16, v16, v20
    v_add_f32 v17, v17, v21
    v_add_f32 v18, v18, v22
    v_add_f32 v19, v19, v23
    v_add_f32 v16, v16, v18
    v_add_f32 v17, v17, v19
    v_add_f32 v16, v16, v17
    buffer_store_dword v16, v5, s[72:75], s23 offen sc1
    s_waitcnt vmcnt(0)
K3_END:
    s_endpgm
.globl k4_ffn1_kernel
.p2align 8
.type k4_ffn1_kernel,@function
k4_ffn1_kernel:
    s_cmp_ge_u32 s2, 224
    s_cbranch_scc1 K4_END
    s_cmp_ge_u32 s2, 8
    s_cbranch_scc1 K4_NOPF
    s_getpc_b64 s[92:93]
K4_PC:
    s_add_u32 s92, s92, k5_down_kernel-K4_PC
    s_addc_u32 s93, s93, 0
    s_mov_b32 s94, K_CODE_END-k5_down_kernel
    s_mov_b32 s95, 0x00020000
    v_lshlrev_b32 v117, 7, v0
    buffer_load_dword v117, v117, s[92:95], 0 offen
K4_NOPF:
    s_load_dwordx2 s[4:5], s[0:1], 32
    s_load_dwordx2 s[6:7], s[0:1], 40
    s_load_dwordx2 s[8:9], s[0:1], 72
    s_load_dwordx2 s[46:47], s[0:1], 48
    s_and_b32 s24, s2, 7
    s_lshr_b32 s25, s2, 3
    s_mul_i32 s20, s25, 9363
    s_lshr_b32 s20, s20, 16
    s_mul_i32 s21, s20, 7
    s_sub_u32 s21, s25, s21
    s_lshr_b32 s26, s24, 1
    s_lshl_b32 s26, s26, 2
    s_add_u32 s20, s20, s26
    s_and_b32 s26, s24, 1
    s_mul_i32 s26, s26, 7
    s_add_u32 s21, s21, s26
    v_lshrrev_b32 v1, 6, v0
    v_and_b32 v2, 63, v0
    s_nop 0
    v_readfirstlane_b32 s22, v1
    v_lshrrev_b32 v185, 3, v2
    s_lshl_b32 s25, s22, 3
    v_add_u32 v185, s25, v185
    v_mul_u32_u24 v185, 0x380, v185
    v_lshrrev_b32 v10, 4, v2
    s_and_b32 s25, s22, 1
    s_lshl_b32 s25, s25, 2
    v_add_u32 v10, s25, v10
    v_and_b32 v11, 7, v2
    v_xor_b32 v10, v10, v11
    v_lshl_add_u32 v185, v10, 4, v185
    s_mul_i32 s23, s20, 0x1c000
    s_add_u32 s33, s23, 0xe000
    s_lshl_b32 s28, s22, 10
    v_lshrrev_b32 v184, 4, v2
    v_lshlrev_b32 v12, 2, v184
    v_and_b32 v13, 15, v2
    v_xor_b32 v12, v12, v13
    s_and_b32 s24, s22, 3
    s_lshl_b32 s25, s24, 3
    v_add_u32 v184, s25, v184
    v_mul_u32_u24 v184, 0xe00, v184
    v_lshl_add_u32 v184, v12, 4, v184
    s_lshl_b32 s25, s21, 8
    v_add_u32 v184, s25, v184
    s_lshr_b32 s26, s22, 2
    s_lshl_b32 s27, s26, 13
    s_lshl_b32 s25, s24, 11
    s_add_u32 s27, s27, s25
    s_add_u32 s27, s27, 114688
    s_waitcnt lgkmcnt(0)
    s_add_u32 s12, s8, 0x800000
    s_addc_u32 s13, s9, 0
    s_mov_b32 s14, 0x1c0000
    s_mov_b32 s15, 0x00020000
    s_cmp_eq_u32 s26, 0
    s_cselect_b32 s72, s4, s6
    s_cselect_b32 s73, s5, s7
    s_mov_b32 s74, 0x188000
    s_mov_b32 s75, 0x00020000
    s_add_u32 m0, s28, 0
    s_nop 0
    buffer_load_dwordx4 v185, s[12:15], s23 offen offset:0 lds
    s_add_u32 m0, s28, 8192
    s_nop 0
    buffer_load_dwordx4 v185, s[12:15], s33 offen offset:0 lds
    s_add_u32 m0, s27, 0
    s_mov_b32 s36, 0x0
    buffer_load_dwordx4 v184, s[72:75], s36 offen lds
    s_add_u32 m0, s27, 1024
    s_mov_b32 s36, 0x3800
    buffer_load_dwordx4 v184, s[72:75], s36 offen lds
    s_barrier
    s_add_u32 m0, s27, 16384
    s_mov_b32 s36, 0x1c000
    buffer_load_dwordx4 v184, s[72:75], s36 offen lds
    s_add_u32 m0, s27, 17408
    s_mov_b32 s36, 0x1f800
    buffer_load_dwordx4 v184, s[72:75], s36 offen lds
    s_add_u32 m0, s28, 16256
    s_nop 0
    buffer_load_dwordx4 v185, s[12:15], s23 offen offset:128 lds
    s_add_u32 m0, s28, 24448
    s_nop 0
    buffer_load_dwordx4 v185, s[12:15], s33 offen offset:128 lds
    s_add_u32 m0, s27, 32768
    s_mov_b32 s36, 0x38000
    buffer_load_dwordx4 v184, s[72:75], s36 offen lds
    s_add_u32 m0, s27, 33792
    s_mov_b32 s36, 0x3b800
    buffer_load_dwordx4 v184, s[72:75], s36 offen lds
    s_add_u32 s68, s8, 0xc00000
    s_addc_u32 s69, s9, 0
    s_mov_b32 s70, 0x700000
    s_mov_b32 s71, 0x00020000
    s_add_u32 s16, s8, 0xa00000
    s_addc_u32 s17, s9, 0
    s_mov_b32 s18, 0x1c000
    s_mov_b32 s19, 0x00020000
    s_add_u32 s64, s8, 0xa20000
    s_addc_u32 s65, s9, 0
    s_mov_b32 s66, 0x3800
    s_mov_b32 s67, 0x00020000
    s_and_b32 s29, s22, 1
    s_lshl_b32 s30, s20, 7
    s_lshl_b32 s31, s29, 6
    s_add_u32 s30, s30, s31
    s_lshl_b32 s30, s30, 3
    s_mov_b32 s50, s30
    v_lshlrev_b32 v116, 3, v2
    s_lshr_b32 s30, s22, 1
    s_lshl_b32 s31, s21, 9
    s_lshl_b32 s32, s30, 7
    s_add_u32 s31, s31, s32
    s_add_u32 s32, s31, 7168
    v_lshrrev_b32 v11, 5, v2
    v_mul_u32_u24 v19, 7168, v11
    v_and_b32 v12, 31, v2
    v_lshl_add_u32 v19, v12, 4, v19
    s_lshl_b32 s51, s21, 9
    v_lshlrev_b32 v18, 4, v11
    s_lshl_b32 s32, s30, 7
    s_add_u32 s32, s32, 147456
    v_add_u32 v18, s32, v18
    s_mov_b32 s40, s46
    s_mov_b32 s41, s47
    s_mov_b32 s42, 0x188000
    s_mov_b32 s43, 0x00020000
    s_lshr_b32 s25, s2, 3
    s_lshl_b32 s25, s25, 3
    s_add_u32 s25, s25, s22
    s_mul_i32 s44, s25, 7168
    v_lshlrev_b32 v3, 4, v2
    v_and_b32 v10, 31, v2
    v_lshrrev_b32 v11, 5, v2
    v_lshrrev_b32 v12, 1, v10
    v_and_b32 v12, 7, v12
    v_xor_b32 v11, v11, v12
    v_lshlrev_b32 v10, 7, v10
    v_lshl_add_u32 v4, v11, 4, v10
    s_lshl_b32 s29, s29, 13
    v_add_u32 v4, s29, v4
    v_xor_b32 v5, 32, v4
    v_xor_b32 v6, 64, v4
    v_xor_b32 v7, 96, v4
    v_lshrrev_b32 v10, 4, v2
    v_and_b32 v11, 1, v10
    v_lshrrev_b32 v12, 1, v10
    v_lshrrev_b32 v13, 2, v2
    v_and_b32 v13, 3, v13
    v_and_b32 v14, 3, v2
    v_lshlrev_b32 v15, 5, v11
    v_lshl_add_u32 v15, v14, 3, v15
    v_xor_b32 v16, s30, v13
    v_lshl_add_u32 v15, v16, 6, v15
    v_lshl_add_u32 v17, v12, 3, v13
    v_lshl_add_u32 v8, v17, 8, v15
    v_add_u32 v8, 114688, v8
    s_waitcnt vmcnt(6)
    s_barrier
    ds_read_b64_tr_b16 v[100:101], v8 offset:0
    ds_read_b64_tr_b16 v[102:103], v8 offset:1024
    ds_read_b64_tr_b16 v[104:105], v8 offset:8192
    ds_read_b64_tr_b16 v[106:107], v8 offset:9216
    ds_read_b128 v[84:87], v4 offset:0
    ds_read_b128 v[88:91], v4 offset:4096
    ds_read_b64_tr_b16 v[108:109], v8 offset:4096
    ds_read_b64_tr_b16 v[110:111], v8 offset:5120
    ds_read_b64_tr_b16 v[112:113], v8 offset:12288
    ds_read_b64_tr_b16 v[114:115], v8 offset:13312
    ds_read_b128 v[92:95], v5 offset:0
    ds_read_b128 v[96:99], v5 offset:4096
    s_waitcnt vmcnt(4) lgkmcnt(0)
    s_barrier
    v_mfma_f32_32x32x16_bf16 v[20:35], v[100:103], v[84:87], 0
    s_add_u32 m0, s28, 32512
    s_nop 0
    buffer_load_dwordx4 v185, s[12:15], s23 offen offset:256 lds
    s_add_u32 m0, s28, 40704
    s_nop 0
    buffer_load_dwordx4 v185, s[12:15], s33 offen offset:256 lds
    s_add_u32 m0, s27, 0
    s_mov_b32 s36, 0x54000
    buffer_load_dwordx4 v184, s[72:75], s36 offen lds
    s_add_u32 m0, s27, 1024
    s_mov_b32 s36, 0x57800
    buffer_load_dwordx4 v184, s[72:75], s36 offen lds
    v_mfma_f32_32x32x16_bf16 v[52:67], v[104:107], v[84:87], 0
    ds_read_b64_tr_b16 v[140:141], v8 offset:16384
    ds_read_b64_tr_b16 v[142:143], v8 offset:17408
    ds_read_b64_tr_b16 v[144:145], v8 offset:24576
    v_mfma_f32_32x32x16_bf16 v[36:51], v[100:103], v[88:91], 0
    ds_read_b64_tr_b16 v[146:147], v8 offset:25600
    ds_read_b128 v[124:127], v6 offset:0
    ds_read_b128 v[128:131], v6 offset:4096
    v_mfma_f32_32x32x16_bf16 v[68:83], v[104:107], v[88:91], 0
    ds_read_b64_tr_b16 v[148:149], v8 offset:20480
    ds_read_b64_tr_b16 v[150:151], v8 offset:21504
    ds_read_b64_tr_b16 v[152:153], v8 offset:28672
    v_mfma_f32_32x32x16_bf16 v[20:35], v[108:111], v[92:95], v[20:35]
    ds_read_b64_tr_b16 v[154:155], v8 offset:29696
    ds_read_b128 v[132:135], v7 offset:0
    ds_read_b128 v[136:139], v7 offset:4096
    v_mfma_f32_32x32x16_bf16 v[52:67], v[112:115], v[92:95], v[52:67]
    buffer_load_dwordx2 v[224:225], v116, s[16:19], s50 offen
    s_add_u32 s50, s50, 0x4000
    v_mfma_f32_32x32x16_bf16 v[36:51], v[108:111], v[96:99], v[36:51]
    buffer_load_dwordx2 v[226:227], v116, s[16:19], s50 offen
    s_add_u32 s50, s50, 0x4000
    v_mfma_f32_32x32x16_bf16 v[68:83], v[112:115], v[96:99], v[68:83]
    s_waitcnt vmcnt(6) lgkmcnt(0)
    s_barrier
    v_mfma_f32_32x32x16_bf16 v[20:35], v[140:143], v[124:127], v[20:35]
    s_add_u32 m0, s27, 16384
    s_mov_b32 s36, 0x70000
    buffer_load_dwordx4 v184, s[72:75], s36 offen lds
    s_add_u32 m0, s27, 17408
    s_mov_b32 s36, 0x73800
    buffer_load_dwordx4 v184, s[72:75], s36 offen lds
    v_mfma_f32_32x32x16_bf16 v[52:67], v[144:147], v[124:127], v[52:67]
    ds_read_b64_tr_b16 v[100:101], v8 offset:32768
    ds_read_b64_tr_b16 v[102:103], v8 offset:33792
    ds_read_b64_tr_b16 v[104:105], v8 offset:40960
    v_mfma_f32_32x32x16_bf16 v[36:51], v[140:143], v[128:131], v[36:51]
    ds_read_b64_tr_b16 v[106:107], v8 offset:41984
    ds_read_b128 v[84:87], v4 offset:16384
    ds_read_b128 v[88:91], v4 offset:20480
    v_mfma_f32_32x32x16_bf16 v[68:83], v[144:147], v[128:131], v[68:83]
    ds_read_b64_tr_b16 v[108:109], v8 offset:36864
    ds_read_b64_tr_b16 v[110:111], v8 offset:37888
    ds_read_b64_tr_b16 v[112:113], v8 offset:45056
    v_mfma_f32_32x32x16_bf16 v[20:35], v[148:151], v[132:135], v[20:35]
    ds_read_b64_tr_b16 v[114:115], v8 offset:46080
    ds_read_b128 v[92:95], v5 offset:16384
    ds_read_b128 v[96:99], v5 offset:20480
    v_mfma_f32_32x32x16_bf16 v[52:67], v[152:155], v[132:135], v[52:67]
    buffer_load_dwordx2 v[228:229], v116, s[16:19], s50 offen
    s_add_u32 s50, s50, 0x4000
    v_mfma_f32_32x32x16_bf16 v[36:51], v[148:151], v[136:139], v[36:51]
    buffer_load_dwordx2 v[230:231], v116, s[16:19], s50 offen
    s_add_u32 s50, s50, 0x4000
    v_mfma_f32_32x32x16_bf16 v[68:83], v[152:155], v[136:139], v[68:83]
    s_waitcnt vmcnt(6) lgkmcnt(0)
    s_barrier
    v_mfma_f32_32x32x16_bf16 v[20:35], v[100:103], v[84:87], v[20:35]
    s_add_u32 m0, s28, 48768
    s_nop 0
    buffer_load_dwordx4 v185, s[12:15], s23 offen offset:384 lds
    s_add_u32 m0, s28, 56960
    s_nop 0
    buffer_load_dwordx4 v185, s[12:15], s33 offen offset:384 lds
    s_add_u32 m0, s27, 32768
    s_mov_b32 s36, 0x8c000
    buffer_load_dwordx4 v184, s[72:75], s36 offen lds
    s_add_u32 m0, s27, 33792
    s_mov_b32 s36, 0x8f800
    buffer_load_dwordx4 v184, s[72:75], s36 offen lds
    v_mfma_f32_32x32x16_bf16 v[52:67], v[104:107], v[84:87], v[52:67]
    ds_read_b64_tr_b16 v[140:141], v8 offset:0
    ds_read_b64_tr_b16 v[142:143], v8 offset:1024
    ds_read_b64_tr_b16 v[144:145], v8 offset:8192
    v_mfma_f32_32x32x16_bf16 v[36:51], v[100:103], v[88:91], v[36:51]
    ds_read_b64_tr_b16 v[146:147], v8 offset:9216
    ds_read_b128 v[124:127], v6 offset:16384
    ds_read_b128 v[128:131], v6 offset:20480
    v_mfma_f32_32x32x16_bf16 v[68:83], v[104:107], v[88:91], v[68:83]
    ds_read_b64_tr_b16 v[148:149], v8 offset:4096
    ds_read_b64_tr_b16 v[150:151], v8 offset:5120
    ds_read_b64_tr_b16 v[152:153], v8 offset:12288
    v_mfma_f32_32x32x16_bf16 v[20:35], v[108:111], v[92:95], v[20:35]
    ds_read_b64_tr_b16 v[154:155], v8 offset:13312
    ds_read_b128 v[132:135], v7 offset:16384
    ds_read_b128 v[136:139], v7 offset:20480
    v_mfma_f32_32x32x16_bf16 v[52:67], v[112:115], v[92:95], v[52:67]
    buffer_load_dwordx2 v[232:233], v116, s[16:19], s50 offen
    s_add_u32 s50, s50, 0x4000
    v_mfma_f32_32x32x16_bf16 v[36:51], v[108:111], v[96:99], v[36:51]
    buffer_load_dwordx2 v[234:235], v116, s[16:19], s50 offen
    s_add_u32 s50, s50, 0x4000
    v_mfma_f32_32x32x16_bf16 v[68:83], v[112:115], v[96:99], v[68:83]
    s_waitcnt vmcnt(8) lgkmcnt(0)
    s_barrier
    v_mfma_f32_32x32x16_bf16 v[20:35], v[140:143], v[124:127], v[20:35]
    s_add_u32 m0, s27, 0
    s_mov_b32 s36, 0xa8000
    buffer_load_dwordx4 v184, s[72:75], s36 offen lds
    s_add_u32 m0, s27, 1024
    s_mov_b32 s36, 0xab800
    buffer_load_dwordx4 v184, s[72:75], s36 offen lds
    v_mfma_f32_32x32x16_bf16 v[52:67], v[144:147], v[124:127], v[52:67]
    ds_read_b64_tr_b16 v[100:101], v8 offset:16384
    ds_read_b64_tr_b16 v[102:103], v8 offset:17408
    ds_read_b64_tr_b16 v[104:105], v8 offset:24576
    v_mfma_f32_32x32x16_bf16 v[36:51], v[140:143], v[128:131], v[36:51]
    ds_read_b64_tr_b16 v[106:107], v8 offset:25600
    ds_read_b128 v[84:87], v4 offset:32768
    ds_read_b128 v[88:91], v4 offset:36864
    v_mfma_f32_32x32x16_bf16 v[68:83], v[144:147], v[128:131], v[68:83]
    ds_read_b64_tr_b16 v[108:109], v8 offset:20480
    ds_read_b64_tr_b16 v[110:111], v8 offset:21504
    ds_read_b64_tr_b16 v[112:113], v8 offset:28672
    v_mfma_f32_32x32x16_bf16 v[20:35], v[148:151], v[132:135], v[20:35]
    ds_read_b64_tr_b16 v[114:115], v8 offset:29696
    ds_read_b128 v[92:95], v5 offset:32768
    ds_read_b128 v[96:99], v5 offset:36864
    v_mfma_f32_32x32x16_bf16 v[52:67], v[152:155], v[132:135], v[52:67]
    buffer_load_dwordx2 v[236:237], v116, s[16:19], s50 offen
    s_add_u32 s50, s50, 0x4000
    v_mfma_f32_32x32x16_bf16 v[36:51], v[148:151], v[136:139], v[36:51]
    v_mfma_f32_32x32x16_bf16 v[68:83], v[152:155], v[136:139], v[68:83]
    s_waitcnt vmcnt(5) lgkmcnt(0)
    s_barrier
    v_mfma_f32_32x32x16_bf16 v[20:35], v[100:103], v[84:87], v[20:35]
    s_add_u32 m0, s28, 65024
    s_nop 0
    buffer_load_dwordx4 v185, s[12:15], s23 offen offset:512 lds
    s_add_u32 m0, s28, 73216
    s_nop 0
    buffer_load_dwordx4 v185, s[12:15], s33 offen offset:512 lds
    s_add_u32 m0, s27, 16384
    s_mov_b32 s36, 0xc4000
    buffer_load_dwordx4 v184, s[72:75], s36 offen lds
    s_add_u32 m0, s27, 17408
    s_mov_b32 s36, 0xc7800
    buffer_load_dwordx4 v184, s[72:75], s36 offen lds
    v_mfma_f32_32x32x16_bf16 v[52:67], v[104:107], v[84:87], v[52:67]
    ds_read_b64_tr_b16 v[140:141], v8 offset:32768
    ds_read_b64_tr_b16 v[142:143], v8 offset:33792
    ds_read_b64_tr_b16 v[144:145], v8 offset:40960
    v_mfma_f32_32x32x16_bf16 v[36:51], v[100:103], v[88:91], v[36:51]
    ds_read_b64_tr_b16 v[146:147], v8 offset:41984
    ds_read_b128 v[124:127], v6 offset:32768
    ds_read_b128 v[128:131], v6 offset:36864
    v_mfma_f32_32x32x16_bf16 v[68:83], v[104:107], v[88:91], v[68:83]
    ds_read_b64_tr_b16 v[148:149], v8 offset:36864
    ds_read_b64_tr_b16 v[150:151], v8 offset:37888
    ds_read_b64_tr_b16 v[152:153], v8 offset:45056
    v_mfma_f32_32x32x16_bf16 v[20:35], v[108:111], v[92:95], v[20:35]
    ds_read_b64_tr_b16 v[154:155], v8 offset:46080
    ds_read_b128 v[132:135], v7 offset:32768
    ds_read_b128 v[136:139], v7 offset:36864
    v_mfma_f32_32x32x16_bf16 v[52:67], v[112:115], v[92:95], v[52:67]
    s_add_u32 s45, s44, 0
    buffer_load_dwordx4 v[176:179], v3, s[40:43], s45 offen
    v_mfma_f32_32x32x16_bf16 v[36:51], v[108:111], v[96:99], v[36:51]
    v_mfma_f32_32x32x16_bf16 v[68:83], v[112:115], v[96:99], v[68:83]
    s_waitcnt vmcnt(6) lgkmcnt(0)
    s_barrier
    v_mfma_f32_32x32x16_bf16 v[20:35], v[140:143], v[124:127], v[20:35]
    s_add_u32 m0, s27, 32768
    s_mov_b32 s36, 0xe0000
    buffer_load_dwordx4 v184, s[72:75], s36 offen lds
    s_add_u32 m0, s27, 33792
    s_mov_b32 s36, 0xe3800
    buffer_load_dwordx4 v184, s[72:75], s36 offen lds
    v_mfma_f32_32x32x16_bf16 v[52:67], v[144:147], v[124:127], v[52:67]
    ds_read_b64_tr_b16 v[100:101], v8 offset:0
    ds_read_b64_tr_b16 v[102:103], v8 offset:1024
    ds_read_b64_tr_b16 v[104:105], v8 offset:8192
    v_mfma_f32_32x32x16_bf16 v[36:51], v[140:143], v[128:131], v[36:51]
    ds_read_b64_tr_b16 v[106:107], v8 offset:9216
    ds_read_b128 v[84:87], v4 offset:49152
    ds_read_b128 v[88:91], v4 offset:53248
    v_mfma_f32_32x32x16_bf16 v[68:83], v[144:147], v[128:131], v[68:83]
    ds_read_b64_tr_b16 v[108:109], v8 offset:4096
    ds_read_b64_tr_b16 v[110:111], v8 offset:5120
    ds_read_b64_tr_b16 v[112:113], v8 offset:12288
    v_mfma_f32_32x32x16_bf16 v[20:35], v[148:151], v[132:135], v[20:35]
    ds_read_b64_tr_b16 v[114:115], v8 offset:13312
    ds_read_b128 v[92:95], v5 offset:49152
    ds_read_b128 v[96:99], v5 offset:53248
    v_mfma_f32_32x32x16_bf16 v[52:67], v[152:155], v[132:135], v[52:67]
    s_add_u32 s45, s44, 1024
    buffer_load_dwordx4 v[176:179], v3, s[40:43], s45 offen
    v_mfma_f32_32x32x16_bf16 v[36:51], v[148:151], v[136:139], v[36:51]
    v_mfma_f32_32x32x16_bf16 v[68:83], v[152:155], v[136:139], v[68:83]
    s_waitcnt vmcnt(4) lgkmcnt(0)
    s_barrier
    v_mfma_f32_32x32x16_bf16 v[20:35], v[100:103], v[84:87], v[20:35]
    s_add_u32 m0, s28, 81280
    s_nop 0
    buffer_load_dwordx4 v185, s[12:15], s23 offen offset:640 lds
    s_add_u32 m0, s28, 89472
    s_nop 0
    buffer_load_dwordx4 v185, s[12:15], s33 offen offset:640 lds
    s_add_u32 m0, s27, 0
    s_mov_b32 s36, 0xfc000
    buffer_load_dwordx4 v184, s[72:75], s36 offen lds
    s_add_u32 m0, s27, 1024
    s_mov_b32 s36, 0xff800
    buffer_load_dwordx4 v184, s[72:75], s36 offen lds
    v_mfma_f32_32x32x16_bf16 v[52:67], v[104:107], v[84:87], v[52:67]
    ds_read_b64_tr_b16 v[140:141], v8 offset:16384
    ds_read_b64_tr_b16 v[142:143], v8 offset:17408
    ds_read_b64_tr_b16 v[144:145], v8 offset:24576
    v_mfma_f32_32x32x16_bf16 v[36:51], v[100:103], v[88:91], v[36:51]
    ds_read_b64_tr_b16 v[146:147], v8 offset:25600
    ds_read_b128 v[124:127], v6 offset:49152
    ds_read_b128 v[128:131], v6 offset:53248
    v_mfma_f32_32x32x16_bf16 v[68:83], v[104:107], v[88:91], v[68:83]
    ds_read_b64_tr_b16 v[148:149], v8 offset:20480
    ds_read_b64_tr_b16 v[150:151], v8 offset:21504
    ds_read_b64_tr_b16 v[152:153], v8 offset:28672
    v_mfma_f32_32x32x16_bf16 v[20:35], v[108:111], v[92:95], v[20:35]
    ds_read_b64_tr_b16 v[154:155], v8 offset:29696
    ds_read_b128 v[132:135], v7 offset:49152
    ds_read_b128 v[136:139], v7 offset:53248
    v_mfma_f32_32x32x16_bf16 v[52:67], v[112:115], v[92:95], v[52:67]
    s_add_u32 s45, s44, 2048
    buffer_load_dwordx4 v[176:179], v3, s[40:43], s45 offen
    v_mfma_f32_32x32x16_bf16 v[36:51], v[108:111], v[96:99], v[36:51]
    v_mfma_f32_32x32x16_bf16 v[68:83], v[112:115], v[96:99], v[68:83]
    s_waitcnt vmcnt(6) lgkmcnt(0)
    s_barrier
    v_mfma_f32_32x32x16_bf16 v[20:35], v[140:143], v[124:127], v[20:35]
    v_add_u32 v4, 0x10000, v4
    v_add_u32 v5, 0x10000, v5
    v_add_u32 v6, 0x10000, v6
    v_add_u32 v7, 0x10000, v7
    s_add_u32 m0, s27, 16384
    s_mov_b32 s36, 0x118000
    buffer_load_dwordx4 v184, s[72:75], s36 offen lds
    s_add_u32 m0, s27, 17408
    s_mov_b32 s36, 0x11b800
    buffer_load_dwordx4 v184, s[72:75], s36 offen lds
    v_add_f32 v250, v224, v226
    v_add_f32 v251, v228, v230
    v_add_f32 v252, v232, v234
    v_add_f32 v253, v225, v227
    v_add_f32 v250, v250, v236
    v_add_f32 v254, v229, v231
    v_add_f32 v251, v251, v252
    v_mfma_f32_32x32x16_bf16 v[52:67], v[144:147], v[124:127], v[52:67]
    ds_read_b64_tr_b16 v[100:101], v8 offset:32768
    ds_read_b64_tr_b16 v[102:103], v8 offset:33792
    ds_read_b64_tr_b16 v[104:105], v8 offset:40960
    v_add_f32 v255, v233, v235
    v_add_f32 v250, v250, v251
    v_add_f32 v253, v253, v237
    v_mul_f32 v250, 0x3e124925, v250
    v_add_f32 v254, v254, v255
    v_sub_f32 v224, v224, v250
    v_sub_f32 v226, v226, v250
    v_mfma_f32_32x32x16_bf16 v[36:51], v[140:143], v[128:131], v[36:51]
    ds_read_b64_tr_b16 v[106:107], v8 offset:41984
    ds_read_b128 v[84:87], v4 offset:0
    ds_read_b128 v[88:91], v4 offset:4096
    v_sub_f32 v228, v228, v250
    v_sub_f32 v230, v230, v250
    v_sub_f32 v232, v232, v250
    v_sub_f32 v234, v234, v250
    v_sub_f32 v236, v236, v250
    v_add_f32 v253, v253, v254
    v_mul_f32 v251, v224, v224
    v_mfma_f32_32x32x16_bf16 v[68:83], v[144:147], v[128:131], v[68:83]
    ds_read_b64_tr_b16 v[108:109], v8 offset:36864
    ds_read_b64_tr_b16 v[110:111], v8 offset:37888
    ds_read_b64_tr_b16 v[112:113], v8 offset:45056
    v_mul_f32 v252, v226, v226
    v_fmac_f32 v251, v228, v228
    v_fmac_f32 v252, v230, v230
    v_fmac_f32 v251, v232, v232
    v_fmac_f32 v252, v234, v234
    v_fmac_f32 v251, v236, v236
    v_add_f32 v251, v251, v252
    v_mfma_f32_32x32x16_bf16 v[20:35], v[148:151], v[132:135], v[20:35]
    ds_read_b64_tr_b16 v[114:115], v8 offset:46080
    ds_read_b128 v[92:95], v5 offset:0
    ds_read_b128 v[96:99], v5 offset:4096
    v_fmac_f32 v253, 0x42800000, v251
    v_mov_b32 v252, 0x3727c5ac
    v_fmac_f32 v252, 0x3b124925, v253
    v_rsq_f32 v251, v252
    s_nop 0
    v_mul_f32 v252, v252, v251
    v_mov_b32 v238, v250
    v_mfma_f32_32x32x16_bf16 v[52:67], v[152:155], v[132:135], v[52:67]
    s_add_u32 s45, s44, 3072
    buffer_load_dwordx4 v[176:179], v3, s[40:43], s45 offen
    v_mov_b32 v244, v250
    v_mov_b32 v240, v251
    v_mov_b32 v246, v251
    v_mov_b32 v242, v252
    v_mov_b32 v248, v252
    s_nop 1
    v_permlane32_swap_b32 v238, v244
    v_mfma_f32_32x32x16_bf16 v[36:51], v[148:151], v[136:139], v[36:51]
    v_permlane32_swap_b32 v240, v246
    v_permlane32_swap_b32 v242, v248
    s_nop 1
    v_mov_b32 v239, v238
    v_mov_b32 v241, v240
    v_mov_b32 v243, v242
    v_mov_b32 v245, v244
    v_mfma_f32_32x32x16_bf16 v[68:83], v[152:155], v[136:139], v[68:83]
    v_mov_b32 v247, v246
    v_mov_b32 v249, v248
    s_waitcnt vmcnt(4) lgkmcnt(0)
    s_barrier
    v_mfma_f32_32x32x16_bf16 v[20:35], v[100:103], v[84:87], v[20:35]
    s_add_u32 m0, s28, 97536
    s_nop 0
    buffer_load_dwordx4 v185, s[12:15], s23 offen offset:768 lds
    s_add_u32 m0, s28, 105728
    s_nop 0
    buffer_load_dwordx4 v185, s[12:15], s33 offen offset:768 lds
    s_add_u32 m0, s27, 32768
    s_mov_b32 s36, 0x134000
    buffer_load_dwordx4 v184, s[72:75], s36 offen lds
    s_add_u32 m0, s27, 33792
    s_mov_b32 s36, 0x137800
    buffer_load_dwordx4 v184, s[72:75], s36 offen lds
    v_mfma_f32_32x32x16_bf16 v[52:67], v[104:107], v[84:87], v[52:67]
    ds_read_b64_tr_b16 v[140:141], v8 offset:0
    ds_read_b64_tr_b16 v[142:143], v8 offset:1024
    ds_read_b64_tr_b16 v[144:145], v8 offset:8192
    v_mfma_f32_32x32x16_bf16 v[36:51], v[100:103], v[88:91], v[36:51]
    ds_read_b64_tr_b16 v[146:147], v8 offset:9216
    ds_read_b128 v[124:127], v6 offset:0
    ds_read_b128 v[128:131], v6 offset:4096
    v_mfma_f32_32x32x16_bf16 v[68:83], v[104:107], v[88:91], v[68:83]
    ds_read_b64_tr_b16 v[148:149], v8 offset:4096
    ds_read_b64_tr_b16 v[150:151], v8 offset:5120
    ds_read_b64_tr_b16 v[152:153], v8 offset:12288
    v_mfma_f32_32x32x16_bf16 v[20:35], v[108:111], v[92:95], v[20:35]
    ds_read_b64_tr_b16 v[154:155], v8 offset:13312
    ds_read_b128 v[132:135], v7 offset:0
    ds_read_b128 v[136:139], v7 offset:4096
    v_mfma_f32_32x32x16_bf16 v[52:67], v[112:115], v[92:95], v[52:67]
    s_add_u32 s45, s44, 4096
    buffer_load_dwordx4 v[176:179], v3, s[40:43], s45 offen
    v_mfma_f32_32x32x16_bf16 v[36:51], v[108:111], v[96:99], v[36:51]
    v_mfma_f32_32x32x16_bf16 v[68:83], v[112:115], v[96:99], v[68:83]
    s_waitcnt vmcnt(6) lgkmcnt(0)
    s_barrier
    v_mfma_f32_32x32x16_bf16 v[20:35], v[140:143], v[124:127], v[20:35]
    s_add_u32 m0, s27, 0
    s_mov_b32 s36, 0x150000
    buffer_load_dwordx4 v184, s[72:75], s36 offen lds
    s_add_u32 m0, s27, 1024
    s_mov_b32 s36, 0x153800
    buffer_load_dwordx4 v184, s[72:75], s36 offen lds
    v_mfma_f32_32x32x16_bf16 v[52:67], v[144:147], v[124:127], v[52:67]
    ds_read_b64_tr_b16 v[100:101], v8 offset:16384
    ds_read_b64_tr_b16 v[102:103], v8 offset:17408
    ds_read_b64_tr_b16 v[104:105], v8 offset:24576
    v_mfma_f32_32x32x16_bf16 v[36:51], v[140:143], v[128:131], v[36:51]
    ds_read_b64_tr_b16 v[106:107], v8 offset:25600
    ds_read_b128 v[84:87], v4 offset:16384
    ds_read_b128 v[88:91], v4 offset:20480
    v_mfma_f32_32x32x16_bf16 v[68:83], v[144:147], v[128:131], v[68:83]
    ds_read_b64_tr_b16 v[108:109], v8 offset:20480
    ds_read_b64_tr_b16 v[110:111], v8 offset:21504
    ds_read_b64_tr_b16 v[112:113], v8 offset:28672
    v_mfma_f32_32x32x16_bf16 v[20:35], v[148:151], v[132:135], v[20:35]
    ds_read_b64_tr_b16 v[114:115], v8 offset:29696
    ds_read_b128 v[92:95], v5 offset:16384
    ds_read_b128 v[96:99], v5 offset:20480
    v_mfma_f32_32x32x16_bf16 v[52:67], v[152:155], v[132:135], v[52:67]
    s_add_u32 s45, s44, 5120
    buffer_load_dwordx4 v[176:179], v3, s[40:43], s45 offen
    v_mfma_f32_32x32x16_bf16 v[36:51], v[148:151], v[136:139], v[36:51]
    v_mfma_f32_32x32x16_bf16 v[68:83], v[152:155], v[136:139], v[68:83]
    s_waitcnt vmcnt(4) lgkmcnt(0)
    s_barrier
    v_mfma_f32_32x32x16_bf16 v[20:35], v[100:103], v[84:87], v[20:35]
    s_add_u32 m0, s27, 16384
    s_mov_b32 s36, 0x16c000
    buffer_load_dwordx4 v184, s[72:75], s36 offen lds
    s_add_u32 m0, s27, 17408
    s_mov_b32 s36, 0x16f800
    buffer_load_dwordx4 v184, s[72:75], s36 offen lds
    v_mfma_f32_32x32x16_bf16 v[52:67], v[104:107], v[84:87], v[52:67]
    ds_read_b64_tr_b16 v[140:141], v8 offset:32768
    ds_read_b64_tr_b16 v[142:143], v8 offset:33792
    ds_read_b64_tr_b16 v[144:145], v8 offset:40960
    v_mfma_f32_32x32x16_bf16 v[36:51], v[100:103], v[88:91], v[36:51]
    ds_read_b64_tr_b16 v[146:147], v8 offset:41984
    ds_read_b128 v[124:127], v6 offset:16384
    ds_read_b128 v[128:131], v6 offset:20480
    v_mfma_f32_32x32x16_bf16 v[68:83], v[104:107], v[88:91], v[68:83]
    ds_read_b64_tr_b16 v[148:149], v8 offset:36864
    ds_read_b64_tr_b16 v[150:151], v8 offset:37888
    ds_read_b64_tr_b16 v[152:153], v8 offset:45056
    v_mfma_f32_32x32x16_bf16 v[20:35], v[108:111], v[92:95], v[20:35]
    ds_read_b64_tr_b16 v[154:155], v8 offset:46080
    ds_read_b128 v[132:135], v7 offset:16384
    ds_read_b128 v[136:139], v7 offset:20480
    v_mfma_f32_32x32x16_bf16 v[52:67], v[112:115], v[92:95], v[52:67]
    s_add_u32 s45, s44, 6144
    buffer_load_dwordx4 v[176:179], v3, s[40:43], s45 offen
    v_mfma_f32_32x32x16_bf16 v[36:51], v[108:111], v[96:99], v[36:51]
    v_mfma_f32_32x32x16_bf16 v[68:83], v[112:115], v[96:99], v[68:83]
    s_waitcnt vmcnt(4) lgkmcnt(0)
    s_barrier
    v_mfma_f32_32x32x16_bf16 v[20:35], v[140:143], v[124:127], v[20:35]
    s_mov_b32 m0, 147456
    s_nop 0
    buffer_load_dwordx4 v19, s[64:67], s51 offen lds
    v_mfma_f32_32x32x16_bf16 v[52:67], v[144:147], v[124:127], v[52:67]
    ds_read_b64_tr_b16 v[100:101], v8 offset:0
    ds_read_b64_tr_b16 v[102:103], v8 offset:1024
    ds_read_b64_tr_b16 v[104:105], v8 offset:8192
    v_mfma_f32_32x32x16_bf16 v[36:51], v[140:143], v[128:131], v[36:51]
    ds_read_b64_tr_b16 v[106:107], v8 offset:9216
    ds_read_b128 v[84:87], v4 offset:32768
    ds_read_b128 v[88:91], v4 offset:36864
    v_mfma_f32_32x32x16_bf16 v[68:83], v[144:147], v[128:131], v[68:83]
    ds_read_b64_tr_b16 v[108:109], v8 offset:4096
    ds_read_b64_tr_b16 v[110:111], v8 offset:5120
    ds_read_b64_tr_b16 v[112:113], v8 offset:12288
    v_mfma_f32_32x32x16_bf16 v[20:35], v[148:151], v[132:135], v[20:35]
    ds_read_b64_tr_b16 v[114:115], v8 offset:13312
    ds_read_b128 v[92:95], v5 offset:32768
    ds_read_b128 v[96:99], v5 offset:36864
    v_mfma_f32_32x32x16_bf16 v[52:67], v[152:155], v[132:135], v[52:67]
    v_mfma_f32_32x32x16_bf16 v[36:51], v[148:151], v[136:139], v[36:51]
    v_mfma_f32_32x32x16_bf16 v[68:83], v[152:155], v[136:139], v[68:83]
    s_waitcnt vmcnt(0) lgkmcnt(0)
    s_barrier
    v_mfma_f32_32x32x16_bf16 v[20:35], v[100:103], v[84:87], v[20:35]
    v_mfma_f32_32x32x16_bf16 v[52:67], v[104:107], v[84:87], v[52:67]
    ds_read_b64_tr_b16 v[140:141], v8 offset:16384
    ds_read_b64_tr_b16 v[142:143], v8 offset:17408
    ds_read_b64_tr_b16 v[144:145], v8 offset:24576
    v_mfma_f32_32x32x16_bf16 v[36:51], v[100:103], v[88:91], v[36:51]
    ds_read_b64_tr_b16 v[146:147], v8 offset:25600
    ds_read_b128 v[124:127], v6 offset:32768
    ds_read_b128 v[128:131], v6 offset:36864
    v_mfma_f32_32x32x16_bf16 v[68:83], v[104:107], v[88:91], v[68:83]
    ds_read_b64_tr_b16 v[148:149], v8 offset:20480
    ds_read_b64_tr_b16 v[150:151], v8 offset:21504
    ds_read_b64_tr_b16 v[152:153], v8 offset:28672
    v_mfma_f32_32x32x16_bf16 v[20:35], v[108:111], v[92:95], v[20:35]
    ds_read_b64_tr_b16 v[154:155], v8 offset:29696
    ds_read_b128 v[132:135], v7 offset:32768
    ds_read_b128 v[136:139], v7 offset:36864
    v_mfma_f32_32x32x16_bf16 v[52:67], v[112:115], v[92:95], v[52:67]
    v_mfma_f32_32x32x16_bf16 v[36:51], v[108:111], v[96:99], v[36:51]
    v_mfma_f32_32x32x16_bf16 v[68:83], v[112:115], v[96:99], v[68:83]
    s_waitcnt lgkmcnt(0)
    v_mfma_f32_32x32x16_bf16 v[20:35], v[140:143], v[124:127], v[20:35]
    ds_read_b128 v[192:195], v18 offset:0
    ds_read_b128 v[196:199], v18 offset:32
    v_mfma_f32_32x32x16_bf16 v[52:67], v[144:147], v[124:127], v[52:67]
    ds_read_b128 v[200:203], v18 offset:64
    ds_read_b128 v[204:207], v18 offset:96
    v_mfma_f32_32x32x16_bf16 v[36:51], v[140:143], v[128:131], v[36:51]
    ds_read_b128 v[208:211], v18 offset:512
    ds_read_b128 v[212:215], v18 offset:544
    v_mfma_f32_32x32x16_bf16 v[68:83], v[144:147], v[128:131], v[68:83]
    ds_read_b128 v[216:219], v18 offset:576
    ds_read_b128 v[220:223], v18 offset:608
    v_mfma_f32_32x32x16_bf16 v[20:35], v[148:151], v[132:135], v[20:35]
    v_mfma_f32_32x32x16_bf16 v[52:67], v[152:155], v[132:135], v[52:67]
    v_mfma_f32_32x32x16_bf16 v[36:51], v[148:151], v[136:139], v[36:51]
    v_mfma_f32_32x32x16_bf16 v[68:83], v[152:155], v[136:139], v[68:83]
    s_nop 15
    s_nop 7
    s_waitcnt lgkmcnt(0)
    v_mov_b32 v10, 0xc0135761
    v_mov_b32 v11, 0xc0135761
    v_mov_b32 v12, 0xbdd2d3e8
    v_mov_b32 v13, 0xbdd2d3e8
    v_lshlrev_b32 v9, 4, v2
    s_lshl_b32 s24, s20, 2
    s_and_b32 s25, s22, 1
    s_lshl_b32 s25, s25, 1
    s_add_u32 s24, s24, s25
    s_mul_i32 s24, s24, 112
    s_lshl_b32 s25, s21, 3
    s_add_u32 s24, s24, s25
    s_lshr_b32 s25, s22, 1
    s_lshl_b32 s25, s25, 1
    s_add_u32 s24, s24, s25
    s_lshl_b32 s24, s24, 10
    v_pk_fma_f32 v[20:21], v[192:193], v[238:239], v[20:21]
    v_pk_fma_f32 v[22:23], v[194:195], v[238:239], v[22:23]
    v_pk_fma_f32 v[24:25], v[196:197], v[238:239], v[24:25]
    v_pk_fma_f32 v[26:27], v[198:199], v[238:239], v[26:27]
    v_pk_fma_f32 v[28:29], v[200:201], v[238:239], v[28:29]
    v_pk_fma_f32 v[30:31], v[202:203], v[238:239], v[30:31]
    v_pk_fma_f32 v[32:33], v[204:205], v[238:239], v[32:33]
    v_pk_fma_f32 v[34:35], v[206:207], v[238:239], v[34:35]
    v_pk_mul_f32 v[20:21], v[20:21], v[240:241]
    v_pk_mul_f32 v[22:23], v[22:23], v[240:241]
    v_pk_mul_f32 v[24:25], v[24:25], v[240:241]
    v_pk_mul_f32 v[26:27], v[26:27], v[240:241]
    v_pk_mul_f32 v[28:29], v[28:29], v[240:241]
    v_pk_mul_f32 v[30:31], v[30:31], v[240:241]
    v_pk_mul_f32 v[32:33], v[32:33], v[240:241]
    v_pk_mul_f32 v[34:35], v[34:35], v[240:241]
    v_pk_mul_f32 v[84:85], v[20:21], v[20:21]
    v_pk_mul_f32 v[86:87], v[22:23], v[22:23]
    v_pk_mul_f32 v[88:89], v[24:25], v[24:25]
    v_pk_mul_f32 v[90:91], v[26:27], v[26:27]
    v_pk_mul_f32 v[92:93], v[28:29], v[28:29]
    v_pk_mul_f32 v[94:95], v[30:31], v[30:31]
    v_pk_mul_f32 v[96:97], v[32:33], v[32:33]
    v_pk_mul_f32 v[98:99], v[34:35], v[34:35]
    v_pk_fma_f32 v[84:85], v[84:85], v[12:13], v[10:11]
    v_pk_fma_f32 v[86:87], v[86:87], v[12:13], v[10:11]
    v_pk_fma_f32 v[88:89], v[88:89], v[12:13], v[10:11]
    v_pk_fma_f32 v[90:91], v[90:91], v[12:13], v[10:11]
    v_pk_fma_f32 v[92:93], v[92:93], v[12:13], v[10:11]
    v_pk_fma_f32 v[94:95], v[94:95], v[12:13], v[10:11]
    v_pk_fma_f32 v[96:97], v[96:97], v[12:13], v[10:11]
    v_pk_fma_f32 v[98:99], v[98:99], v[12:13], v[10:11]
    v_pk_mul_f32 v[84:85], v[84:85], v[20:21]
    v_pk_mul_f32 v[86:87], v[86:87], v[22:23]
    v_pk_mul_f32 v[88:89], v[88:89], v[24:25]
    v_pk_mul_f32 v[90:91], v[90:91], v[26:27]
    v_pk_mul_f32 v[92:93], v[92:93], v[28:29]
    v_pk_mul_f32 v[94:95], v[94:95], v[30:31]
    v_pk_mul_f32 v[96:97], v[96:97], v[32:33]
    v_pk_mul_f32 v[98:99], v[98:99], v[34:35]
    v_exp_f32 v84, v84
    v_pk_fma_f32 v[52:53], v[208:209], v[238:239], v[52:53]
    v_exp_f32 v85, v85
    v_exp_f32 v86, v86
    v_pk_fma_f32 v[54:55], v[210:211], v[238:239], v[54:55]
    v_exp_f32 v87, v87
    v_exp_f32 v88, v88
    v_pk_fma_f32 v[56:57], v[212:213], v[238:239], v[56:57]
    v_exp_f32 v89, v89
    v_exp_f32 v90, v90
    v_pk_fma_f32 v[58:59], v[214:215], v[238:239], v[58:59]
    v_exp_f32 v91, v91
    v_exp_f32 v92, v92
    v_pk_fma_f32 v[60:61], v[216:217], v[238:239], v[60:61]
    v_exp_f32 v93, v93
    v_exp_f32 v94, v94
    v_pk_fma_f32 v[62:63], v[218:219], v[238:239], v[62:63]
    v_exp_f32 v95, v95
    v_exp_f32 v96, v96
    v_pk_fma_f32 v[64:65], v[220:221], v[238:239], v[64:65]
    v_exp_f32 v97, v97
    v_exp_f32 v98, v98
    v_pk_fma_f32 v[66:67], v[222:223], v[238:239], v[66:67]
    v_exp_f32 v99, v99
    v_pk_mul_f32 v[52:53], v[52:53], v[20:21]
    v_pk_fma_f32 v[84:85], v[84:85], v[242:243], v[242:243]
    v_pk_mul_f32 v[54:55], v[54:55], v[22:23]
    v_pk_fma_f32 v[86:87], v[86:87], v[242:243], v[242:243]
    v_pk_mul_f32 v[56:57], v[56:57], v[24:25]
    v_pk_fma_f32 v[88:89], v[88:89], v[242:243], v[242:243]
    v_pk_mul_f32 v[58:59], v[58:59], v[26:27]
    v_pk_fma_f32 v[90:91], v[90:91], v[242:243], v[242:243]
    v_pk_mul_f32 v[60:61], v[60:61], v[28:29]
    v_pk_fma_f32 v[92:93], v[92:93], v[242:243], v[242:243]
    v_pk_mul_f32 v[62:63], v[62:63], v[30:31]
    v_pk_fma_f32 v[94:95], v[94:95], v[242:243], v[242:243]
    v_pk_mul_f32 v[64:65], v[64:65], v[32:33]
    v_pk_fma_f32 v[96:97], v[96:97], v[242:243], v[242:243]
    v_pk_mul_f32 v[66:67], v[66:67], v[34:35]
    v_pk_fma_f32 v[98:99], v[98:99], v[242:243], v[242:243]
    v_rcp_f32 v84, v84
    v_rcp_f32 v85, v85
    v_rcp_f32 v86, v86
    v_rcp_f32 v87, v87
    v_rcp_f32 v88, v88
    v_rcp_f32 v89, v89
    v_rcp_f32 v90, v90
    v_rcp_f32 v91, v91
    v_rcp_f32 v92, v92
    v_rcp_f32 v93, v93
    v_rcp_f32 v94, v94
    v_rcp_f32 v95, v95
    v_rcp_f32 v96, v96
    v_rcp_f32 v97, v97
    v_rcp_f32 v98, v98
    v_rcp_f32 v99, v99
    v_pk_mul_f32 v[52:53], v[52:53], v[84:85]
    v_pk_mul_f32 v[54:55], v[54:55], v[86:87]
    v_pk_mul_f32 v[56:57], v[56:57], v[88:89]
    v_pk_mul_f32 v[58:59], v[58:59], v[90:91]
    v_pk_mul_f32 v[60:61], v[60:61], v[92:93]
    v_pk_mul_f32 v[62:63], v[62:63], v[94:95]
    v_pk_mul_f32 v[64:65], v[64:65], v[96:97]
    v_pk_mul_f32 v[66:67], v[66:67], v[98:99]
    v_cvt_pk_bf16_f32 v20, v52, v53
    v_cvt_pk_bf16_f32 v21, v54, v55
    v_cvt_pk_bf16_f32 v22, v56, v57
    v_cvt_pk_bf16_f32 v23, v58, v59
    v_cvt_pk_bf16_f32 v24, v60, v61
    v_cvt_pk_bf16_f32 v25, v62, v63
    v_cvt_pk_bf16_f32 v26, v64, v65
    v_cvt_pk_bf16_f32 v27, v66, v67
    buffer_store_dwordx4 v[20:23], v9, s[68:71], s24 offen sc1
    buffer_store_dwordx4 v[24:27], v9, s[68:71], s24 offen offset:1024 sc1
    v_pk_fma_f32 v[36:37], v[192:193], v[244:245], v[36:37]
    v_pk_fma_f32 v[38:39], v[194:195], v[244:245], v[38:39]
    v_pk_fma_f32 v[40:41], v[196:197], v[244:245], v[40:41]
    v_pk_fma_f32 v[42:43], v[198:199], v[244:245], v[42:43]
    v_pk_fma_f32 v[44:45], v[200:201], v[244:245], v[44:45]
    v_pk_fma_f32 v[46:47], v[202:203], v[244:245], v[46:47]
    v_pk_fma_f32 v[48:49], v[204:205], v[244:245], v[48:49]
    v_pk_fma_f32 v[50:51], v[206:207], v[244:245], v[50:51]
    v_pk_mul_f32 v[36:37], v[36:37], v[246:247]
    v_pk_mul_f32 v[38:39], v[38:39], v[246:247]
    v_pk_mul_f32 v[40:41], v[40:41], v[246:247]
    v_pk_mul_f32 v[42:43], v[42:43], v[246:247]
    v_pk_mul_f32 v[44:45], v[44:45], v[246:247]
    v_pk_mul_f32 v[46:47], v[46:47], v[246:247]
    v_pk_mul_f32 v[48:49], v[48:49], v[246:247]
    v_pk_mul_f32 v[50:51], v[50:51], v[246:247]
    v_pk_mul_f32 v[100:101], v[36:37], v[36:37]
    v_pk_mul_f32 v[102:103], v[38:39], v[38:39]
    v_pk_mul_f32 v[104:105], v[40:41], v[40:41]
    v_pk_mul_f32 v[106:107], v[42:43], v[42:43]
    v_pk_mul_f32 v[108:109], v[44:45], v[44:45]
    v_pk_mul_f32 v[110:111], v[46:47], v[46:47]
    v_pk_mul_f32 v[112:113], v[48:49], v[48:49]
    v_pk_mul_f32 v[114:115], v[50:51], v[50:51]
    v_pk_fma_f32 v[100:101], v[100:101], v[12:13], v[10:11]
    v_pk_fma_f32 v[102:103], v[102:103], v[12:13], v[10:11]
    v_pk_fma_f32 v[104:105], v[104:105], v[12:13], v[10:11]
    v_pk_fma_f32 v[106:107], v[106:107], v[12:13], v[10:11]
    v_pk_fma_f32 v[108:109], v[108:109], v[12:13], v[10:11]
    v_pk_fma_f32 v[110:111], v[110:111], v[12:13], v[10:11]
    v_pk_fma_f32 v[112:113], v[112:113], v[12:13], v[10:11]
    v_pk_fma_f32 v[114:115], v[114:115], v[12:13], v[10:11]
    v_pk_mul_f32 v[100:101], v[100:101], v[36:37]
    v_pk_mul_f32 v[102:103], v[102:103], v[38:39]
    v_pk_mul_f32 v[104:105], v[104:105], v[40:41]
    v_pk_mul_f32 v[106:107], v[106:107], v[42:43]
    v_pk_mul_f32 v[108:109], v[108:109], v[44:45]
    v_pk_mul_f32 v[110:111], v[110:111], v[46:47]
    v_pk_mul_f32 v[112:113], v[112:113], v[48:49]
    v_pk_mul_f32 v[114:115], v[114:115], v[50:51]
    v_exp_f32 v100, v100
    v_pk_fma_f32 v[68:69], v[208:209], v[244:245], v[68:69]
    v_exp_f32 v101, v101
    v_exp_f32 v102, v102
    v_pk_fma_f32 v[70:71], v[210:211], v[244:245], v[70:71]
    v_exp_f32 v103, v103
    v_exp_f32 v104, v104
    v_pk_fma_f32 v[72:73], v[212:213], v[244:245], v[72:73]
    v_exp_f32 v105, v105
    v_exp_f32 v106, v106
    v_pk_fma_f32 v[74:75], v[214:215], v[244:245], v[74:75]
    v_exp_f32 v107, v107
    v_exp_f32 v108, v108
    v_pk_fma_f32 v[76:77], v[216:217], v[244:245], v[76:77]
    v_exp_f32 v109, v109
    v_exp_f32 v110, v110
    v_pk_fma_f32 v[78:79], v[218:219], v[244:245], v[78:79]
    v_exp_f32 v111, v111
    v_exp_f32 v112, v112
    v_pk_fma_f32 v[80:81], v[220:221], v[244:245], v[80:81]
    v_exp_f32 v113, v113
    v_exp_f32 v114, v114
    v_pk_fma_f32 v[82:83], v[222:223], v[244:245], v[82:83]
    v_exp_f32 v115, v115
    v_pk_mul_f32 v[68:69], v[68:69], v[36:37]
    v_pk_fma_f32 v[100:101], v[100:101], v[248:249], v[248:249]
    v_pk_mul_f32 v[70:71], v[70:71], v[38:39]
    v_pk_fma_f32 v[102:103], v[102:103], v[248:249], v[248:249]
    v_pk_mul_f32 v[72:73], v[72:73], v[40:41]
    v_pk_fma_f32 v[104:105], v[104:105], v[248:249], v[248:249]
    v_pk_mul_f32 v[74:75], v[74:75], v[42:43]
    v_pk_fma_f32 v[106:107], v[106:107], v[248:249], v[248:249]
    v_pk_mul_f32 v[76:77], v[76:77], v[44:45]
    v_pk_fma_f32 v[108:109], v[108:109], v[248:249], v[248:249]
    v_pk_mul_f32 v[78:79], v[78:79], v[46:47]
    v_pk_fma_f32 v[110:111], v[110:111], v[248:249], v[248:249]
    v_pk_mul_f32 v[80:81], v[80:81], v[48:49]
    v_pk_fma_f32 v[112:113], v[112:113], v[248:249], v[248:249]
    v_pk_mul_f32 v[82:83], v[82:83], v[50:51]
    v_pk_fma_f32 v[114:115], v[114:115], v[248:249], v[248:249]
    v_rcp_f32 v100, v100
    v_rcp_f32 v101, v101
    v_rcp_f32 v102, v102
    v_rcp_f32 v103, v103
    v_rcp_f32 v104, v104
    v_rcp_f32 v105, v105
    v_rcp_f32 v106, v106
    v_rcp_f32 v107, v107
    v_rcp_f32 v108, v108
    v_rcp_f32 v109, v109
    v_rcp_f32 v110, v110
    v_rcp_f32 v111, v111
    v_rcp_f32 v112, v112
    v_rcp_f32 v113, v113
    v_rcp_f32 v114, v114
    v_rcp_f32 v115, v115
    v_pk_mul_f32 v[68:69], v[68:69], v[100:101]
    v_pk_mul_f32 v[70:71], v[70:71], v[102:103]
    v_pk_mul_f32 v[72:73], v[72:73], v[104:105]
    v_pk_mul_f32 v[74:75], v[74:75], v[106:107]
    v_pk_mul_f32 v[76:77], v[76:77], v[108:109]
    v_pk_mul_f32 v[78:79], v[78:79], v[110:111]
    v_pk_mul_f32 v[80:81], v[80:81], v[112:113]
    v_pk_mul_f32 v[82:83], v[82:83], v[114:115]
    v_cvt_pk_bf16_f32 v36, v68, v69
    v_cvt_pk_bf16_f32 v37, v70, v71
    v_cvt_pk_bf16_f32 v38, v72, v73
    v_cvt_pk_bf16_f32 v39, v74, v75
    v_cvt_pk_bf16_f32 v40, v76, v77
    v_cvt_pk_bf16_f32 v41, v78, v79
    v_cvt_pk_bf16_f32 v42, v80, v81
    v_cvt_pk_bf16_f32 v43, v82, v83
    s_add_u32 s24, s24, 114688
    buffer_store_dwordx4 v[36:39], v9, s[68:71], s24 offen sc1
    buffer_store_dwordx4 v[40:43], v9, s[68:71], s24 offen offset:1024 sc1
    s_waitcnt vmcnt(0)
K4_END:
    s_endpgm
.globl k5_down_kernel
.p2align 8
.type k5_down_kernel,@function
k5_down_kernel:
    s_cmp_ge_u32 s2, 224
    s_cbranch_scc1 K5_END
    s_load_dwordx2 s[4:5], s[0:1], 48
    s_load_dwordx2 s[6:7], s[0:1], 56
    s_load_dwordx2 s[8:9], s[0:1], 72
    s_and_b32 s24, s2, 7
    s_lshr_b32 s25, s2, 3
    s_mul_i32 s20, s25, 9363
    s_lshr_b32 s20, s20, 16
    s_mul_i32 s21, s20, 7
    s_sub_u32 s21, s25, s21
    s_lshl_b32 s24, s24, 2
    s_add_u32 s20, s20, s24
    v_lshrrev_b32 v1, 6, v0
    v_and_b32 v2, 63, v0
    s_nop 0
    v_readfirstlane_b32 s22, v1
    s_waitcnt lgkmcnt(0)
    s_mov_b32 s12, s4
    s_mov_b32 s13, s5
    s_mov_b32 s14, 0x188000
    s_mov_b32 s15, 0x00020000
    s_mov_b32 s16, s6
    s_mov_b32 s17, s7
    s_mov_b32 s18, 0x1c0000
    s_mov_b32 s19, 0x00020000
    s_add_u32 s64, s8, 0xc00000
    s_addc_u32 s65, s9, 0
    s_mov_b32 s66, 0x700000
    s_mov_b32 s67, 0x00020000
    s_add_u32 s68, s8, 0x800000
    s_addc_u32 s69, s9, 0
    s_mov_b32 s70, 0x1c0000
    s_mov_b32 s71, 0x00020000
    v_lshrrev_b32 v3, 3, v2
    v_mul_u32_u24 v3, 0x380, v3
    v_lshrrev_b32 v4, 4, v2
    v_and_b32 v4, 1, v4
    v_lshlrev_b32 v4, 2, v4
    v_and_b32 v5, 7, v2
    v_xor_b32 v4, v4, v5
    v_lshl_add_u32 v3, v4, 4, v3
    s_lshl_b32 s25, s21, 7
    v_add_u32 v3, s25, v3
    s_lshl_b32 s26, s22, 14
    s_and_b32 s33, s2, 1
    s_lshl_b32 s33, s33, 2
    s_xor_b32 s33, s33, s22
    s_mul_i32 s27, s33, 200704
    v_lshlrev_b32 v4, 4, v2
    s_mul_i32 s28, s20, 224
    s_mul_i32 s29, s33, 14
    s_add_u32 s28, s28, s29
    s_lshl_b32 s28, s28, 10
    s_add_u32 s29, s28, 114688
    s_add_u32 m0, s26, 0
    s_add_u32 s32, s27, 0
    buffer_load_dwordx4 v3, s[12:15], s32 offen lds
    s_add_u32 m0, s26, 1024
    s_add_u32 s32, s27, 7168
    buffer_load_dwordx4 v3, s[12:15], s32 offen lds
    buffer_load_dwordx4 v[96:99], v4, s[64:67], s28 offen offset:0
    buffer_load_dwordx4 v[100:103], v4, s[64:67], s29 offen offset:0
    s_add_u32 m0, s26, 2048
    s_add_u32 s32, s27, 14336
    buffer_load_dwordx4 v3, s[12:15], s32 offen lds
    s_add_u32 m0, s26, 3072
    s_add_u32 s32, s27, 21504
    buffer_load_dwordx4 v3, s[12:15], s32 offen lds
    buffer_load_dwordx4 v[104:107], v4, s[64:67], s28 offen offset:1024
    buffer_load_dwordx4 v[108:111], v4, s[64:67], s29 offen offset:1024
    s_add_u32 m0, s26, 4096
    s_add_u32 s32, s27, 28672
    buffer_load_dwordx4 v3, s[12:15], s32 offen lds
    s_add_u32 m0, s26, 5120
    s_add_u32 s32, s27, 35840
    buffer_load_dwordx4 v3, s[12:15], s32 offen lds
    buffer_load_dwordx4 v[112:115], v4, s[64:67], s28 offen offset:2048
    buffer_load_dwordx4 v[116:119], v4, s[64:67], s29 offen offset:2048
    s_add_u32 m0, s26, 6144
    s_add_u32 s32, s27, 43008
    buffer_load_dwordx4 v3, s[12:15], s32 offen lds
    s_add_u32 m0, s26, 7168
    s_add_u32 s32, s27, 50176
    buffer_load_dwordx4 v3, s[12:15], s32 offen lds
    buffer_load_dwordx4 v[120:123], v4, s[64:67], s28 offen offset:3072
    buffer_load_dwordx4 v[124:127], v4, s[64:67], s29 offen offset:3072
    s_add_u32 m0, s26, 8192
    s_add_u32 s32, s27, 57344
    buffer_load_dwordx4 v3, s[12:15], s32 offen lds
    s_add_u32 m0, s26, 9216
    s_add_u32 s32, s27, 64512
    buffer_load_dwordx4 v3, s[12:15], s32 offen lds
    s_add_u32 s28, s28, 4096
    s_add_u32 s29, s29, 4096
    buffer_load_dwordx4 v[128:131], v4, s[64:67], s28 offen offset:0
    buffer_load_dwordx4 v[132:135], v4, s[64:67], s29 offen offset:0
    v_lshrrev_b32 v5, 3, v2
    s_lshl_b32 s30, s22, 3
    v_add_u32 v5, s30, v5
    v_mul_u32_u24 v5, 0x380, v5
    v_and_b32 v6, 7, v2
    v_lshl_add_u32 v5, v6, 4, v5
    s_mul_i32 s31, s20, 0xe000
    s_lshl_b32 s30, s21, 7
    s_add_u32 s31, s31, s30
    buffer_load_dwordx4 v[12:15], v5, s[68:71], s31 offen
    v_lshrrev_b32 v80, 4, v2
    v_and_b32 v81, 1, v80
    v_lshrrev_b32 v82, 1, v80
    v_lshrrev_b32 v83, 2, v2
    v_and_b32 v83, 3, v83
    v_and_b32 v84, 3, v2
    v_lshlrev_b32 v85, 5, v81
    v_lshl_add_u32 v85, v84, 3, v85
    v_lshrrev_b32 v81, 1, v83
    v_lshlrev_b32 v81, 6, v81
    v_xor_b32 v85, v81, v85
    v_lshl_add_u32 v82, v82, 2, v83
    v_lshl_add_u32 v8, v82, 7, v85
    v_add_u32 v8, s26, v8
    v_xor_b32 v9, 64, v8
    s_waitcnt vmcnt(17)
    s_add_u32 m0, s26, 10240
    s_add_u32 s32, s27, 71680
    buffer_load_dwordx4 v3, s[12:15], s32 offen lds
    s_add_u32 m0, s26, 11264
    s_add_u32 s32, s27, 78848
    buffer_load_dwordx4 v3, s[12:15], s32 offen lds
    buffer_load_dwordx4 v[136:139], v4, s[64:67], s28 offen offset:1024
    buffer_load_dwordx4 v[140:143], v4, s[64:67], s29 offen offset:1024
    ds_read_b64_tr_b16 v[80:81], v8 offset:0
    ds_read_b64_tr_b16 v[82:83], v8 offset:1024
    ds_read_b64_tr_b16 v[84:85], v9 offset:0
    ds_read_b64_tr_b16 v[86:87], v9 offset:1024
    s_waitcnt lgkmcnt(0)
    v_mfma_f32_32x32x16_bf16 v[16:31], v[80:83], v[96:99], 0
    v_mfma_f32_32x32x16_bf16 v[32:47], v[84:87], v[96:99], 0
    v_mfma_f32_32x32x16_bf16 v[48:63], v[80:83], v[100:103], 0
    v_mfma_f32_32x32x16_bf16 v[64:79], v[84:87], v[100:103], 0
    s_waitcnt vmcnt(17)
    s_add_u32 m0, s26, 12288
    s_add_u32 s32, s27, 86016
    buffer_load_dwordx4 v3, s[12:15], s32 offen lds
    s_add_u32 m0, s26, 13312
    s_add_u32 s32, s27, 93184
    buffer_load_dwordx4 v3, s[12:15], s32 offen lds
    buffer_load_dwordx4 v[144:147], v4, s[64:67], s28 offen offset:2048
    buffer_load_dwordx4 v[148:151], v4, s[64:67], s29 offen offset:2048
    ds_read_b64_tr_b16 v[88:89], v8 offset:2048
    ds_read_b64_tr_b16 v[90:91], v8 offset:3072
    ds_read_b64_tr_b16 v[92:93], v9 offset:2048
    ds_read_b64_tr_b16 v[94:95], v9 offset:3072
    s_waitcnt lgkmcnt(0)
    v_mfma_f32_32x32x16_bf16 v[16:31], v[88:91], v[104:107], v[16:31]
    v_mfma_f32_32x32x16_bf16 v[32:47], v[92:95], v[104:107], v[32:47]
    v_mfma_f32_32x32x16_bf16 v[48:63], v[88:91], v[108:111], v[48:63]
    v_mfma_f32_32x32x16_bf16 v[64:79], v[92:95], v[108:111], v[64:79]
    s_waitcnt vmcnt(17)
    s_add_u32 m0, s26, 14336
    s_add_u32 s32, s27, 100352
    buffer_load_dwordx4 v3, s[12:15], s32 offen lds
    s_add_u32 m0, s26, 15360
    s_add_u32 s32, s27, 107520
    buffer_load_dwordx4 v3, s[12:15], s32 offen lds
    buffer_load_dwordx4 v[152:155], v4, s[64:67], s28 offen offset:3072
    buffer_load_dwordx4 v[156:159], v4, s[64:67], s29 offen offset:3072
    ds_read_b64_tr_b16 v[80:81], v8 offset:4096
    ds_read_b64_tr_b16 v[82:83], v8 offset:5120
    ds_read_b64_tr_b16 v[84:85], v9 offset:4096
    ds_read_b64_tr_b16 v[86:87], v9 offset:5120
    s_waitcnt lgkmcnt(0)
    v_mfma_f32_32x32x16_bf16 v[16:31], v[80:83], v[112:115], v[16:31]
    v_mfma_f32_32x32x16_bf16 v[32:47], v[84:87], v[112:115], v[32:47]
    v_mfma_f32_32x32x16_bf16 v[48:63], v[80:83], v[116:119], v[48:63]
    v_mfma_f32_32x32x16_bf16 v[64:79], v[84:87], v[116:119], v[64:79]
    s_waitcnt vmcnt(17)
    s_add_u32 m0, s26, 0
    s_add_u32 s32, s27, 114688
    buffer_load_dwordx4 v3, s[12:15], s32 offen lds
    s_add_u32 m0, s26, 1024
    s_add_u32 s32, s27, 121856
    buffer_load_dwordx4 v3, s[12:15], s32 offen lds
    s_add_u32 s28, s28, 4096
    s_add_u32 s29, s29, 4096
    buffer_load_dwordx4 v[160:163], v4, s[64:67], s28 offen offset:0
    buffer_load_dwordx4 v[164:167], v4, s[64:67], s29 offen offset:0
    ds_read_b64_tr_b16 v[88:89], v8 offset:6144
    ds_read_b64_tr_b16 v[90:91], v8 offset:7168
    ds_read_b64_tr_b16 v[92:93], v9 offset:6144
    ds_read_b64_tr_b16 v[94:95], v9 offset:7168
    s_waitcnt lgkmcnt(0)
    v_mfma_f32_32x32x16_bf16 v[16:31], v[88:91], v[120:123], v[16:31]
    v_mfma_f32_32x32x16_bf16 v[32:47], v[92:95], v[120:123], v[32:47]
    v_mfma_f32_32x32x16_bf16 v[48:63], v[88:91], v[124:127], v[48:63]
    v_mfma_f32_32x32x16_bf16 v[64:79], v[92:95], v[124:127], v[64:79]
    s_waitcnt vmcnt(17)
    s_add_u32 m0, s26, 2048
    s_add_u32 s32, s27, 129024
    buffer_load_dwordx4 v3, s[12:15], s32 offen lds
    s_add_u32 m0, s26, 3072
    s_add_u32 s32, s27, 136192
    buffer_load_dwordx4 v3, s[12:15], s32 offen lds
    buffer_load_dwordx4 v[168:171], v4, s[64:67], s28 offen offset:1024
    buffer_load_dwordx4 v[172:175], v4, s[64:67], s29 offen offset:1024
    ds_read_b64_tr_b16 v[80:81], v8 offset:8192
    ds_read_b64_tr_b16 v[82:83], v8 offset:9216
    ds_read_b64_tr_b16 v[84:85], v9 offset:8192
    ds_read_b64_tr_b16 v[86:87], v9 offset:9216
    s_waitcnt lgkmcnt(0)
    v_mfma_f32_32x32x16_bf16 v[16:31], v[80:83], v[128:131], v[16:31]
    v_mfma_f32_32x32x16_bf16 v[32:47], v[84:87], v[128:131], v[32:47]
    v_mfma_f32_32x32x16_bf16 v[48:63], v[80:83], v[132:135], v[48:63]
    v_mfma_f32_32x32x16_bf16 v[64:79], v[84:87], v[132:135], v[64:79]
    s_waitcnt vmcnt(16)
    s_add_u32 m0, s26, 4096
    s_add_u32 s32, s27, 143360
    buffer_load_dwordx4 v3, s[12:15], s32 offen lds
    s_add_u32 m0, s26, 5120
    s_add_u32 s32, s27, 150528
    buffer_load_dwordx4 v3, s[12:15], s32 offen lds
    buffer_load_dwordx4 v[176:179], v4, s[64:67], s28 offen offset:2048
    buffer_load_dwordx4 v[180:183], v4, s[64:67], s29 offen offset:2048
    ds_read_b64_tr_b16 v[88:89], v8 offset:10240
    ds_read_b64_tr_b16 v[90:91], v8 offset:11264
    ds_read_b64_tr_b16 v[92:93], v9 offset:10240
    ds_read_b64_tr_b16 v[94:95], v9 offset:11264
    s_waitcnt lgkmcnt(0)
    v_mfma_f32_32x32x16_bf16 v[16:31], v[88:91], v[136:139], v[16:31]
    v_mfma_f32_32x32x16_bf16 v[32:47], v[92:95], v[136:139], v[32:47]
    v_mfma_f32_32x32x16_bf16 v[48:63], v[88:91], v[140:143], v[48:63]
    v_mfma_f32_32x32x16_bf16 v[64:79], v[92:95], v[140:143], v[64:79]
    s_waitcnt vmcnt(16)
    s_add_u32 m0, s26, 6144
    s_add_u32 s32, s27, 157696
    buffer_load_dwordx4 v3, s[12:15], s32 offen lds
    s_add_u32 m0, s26, 7168
    s_add_u32 s32, s27, 164864
    buffer_load_dwordx4 v3, s[12:15], s32 offen lds
    buffer_load_dwordx4 v[184:187], v4, s[64:67], s28 offen offset:3072
    buffer_load_dwordx4 v[188:191], v4, s[64:67], s29 offen offset:3072
    ds_read_b64_tr_b16 v[80:81], v8 offset:12288
    ds_read_b64_tr_b16 v[82:83], v8 offset:13312
    ds_read_b64_tr_b16 v[84:85], v9 offset:12288
    ds_read_b64_tr_b16 v[86:87], v9 offset:13312
    s_waitcnt lgkmcnt(0)
    v_mfma_f32_32x32x16_bf16 v[16:31], v[80:83], v[144:147], v[16:31]
    v_mfma_f32_32x32x16_bf16 v[32:47], v[84:87], v[144:147], v[32:47]
    v_mfma_f32_32x32x16_bf16 v[48:63], v[80:83], v[148:151], v[48:63]
    v_mfma_f32_32x32x16_bf16 v[64:79], v[84:87], v[148:151], v[64:79]
    s_waitcnt vmcnt(16)
    s_add_u32 m0, s26, 8192
    s_add_u32 s32, s27, 172032
    buffer_load_dwordx4 v3, s[12:15], s32 offen lds
    s_add_u32 m0, s26, 9216
    s_add_u32 s32, s27, 179200
    buffer_load_dwordx4 v3, s[12:15], s32 offen lds
    s_add_u32 s28, s28, 4096
    s_add_u32 s29, s29, 4096
    buffer_load_dwordx4 v[192:195], v4, s[64:67], s28 offen offset:0
    buffer_load_dwordx4 v[196:199], v4, s[64:67], s29 offen offset:0
    ds_read_b64_tr_b16 v[88:89], v8 offset:14336
    ds_read_b64_tr_b16 v[90:91], v8 offset:15360
    ds_read_b64_tr_b16 v[92:93], v9 offset:14336
    ds_read_b64_tr_b16 v[94:95], v9 offset:15360
    s_waitcnt lgkmcnt(0)
    v_mfma_f32_32x32x16_bf16 v[16:31], v[88:91], v[152:155], v[16:31]
    v_mfma_f32_32x32x16_bf16 v[32:47], v[92:95], v[152:155], v[32:47]
    v_mfma_f32_32x32x16_bf16 v[48:63], v[88:91], v[156:159], v[48:63]
    v_mfma_f32_32x32x16_bf16 v[64:79], v[92:95], v[156:159], v[64:79]
    s_waitcnt vmcnt(16)
    s_add_u32 m0, s26, 10240
    s_add_u32 s32, s27, 186368
    buffer_load_dwordx4 v3, s[12:15], s32 offen lds
    s_add_u32 m0, s26, 11264
    s_add_u32 s32, s27, 193536
    buffer_load_dwordx4 v3, s[12:15], s32 offen lds
    buffer_load_dwordx4 v[200:203], v4, s[64:67], s28 offen offset:1024
    buffer_load_dwordx4 v[204:207], v4, s[64:67], s29 offen offset:1024
    ds_read_b64_tr_b16 v[80:81], v8 offset:0
    ds_read_b64_tr_b16 v[82:83], v8 offset:1024
    ds_read_b64_tr_b16 v[84:85], v9 offset:0
    ds_read_b64_tr_b16 v[86:87], v9 offset:1024
    s_waitcnt lgkmcnt(0)
    v_mfma_f32_32x32x16_bf16 v[16:31], v[80:83], v[160:163], v[16:31]
    v_mfma_f32_32x32x16_bf16 v[32:47], v[84:87], v[160:163], v[32:47]
    v_mfma_f32_32x32x16_bf16 v[48:63], v[80:83], v[164:167], v[48:63]
    v_mfma_f32_32x32x16_bf16 v[64:79], v[84:87], v[164:167], v[64:79]
    s_waitcnt vmcnt(16)
    ds_read_b64_tr_b16 v[88:89], v8 offset:2048
    ds_read_b64_tr_b16 v[90:91], v8 offset:3072
    ds_read_b64_tr_b16 v[92:93], v9 offset:2048
    ds_read_b64_tr_b16 v[94:95], v9 offset:3072
    s_waitcnt lgkmcnt(0)
    v_mfma_f32_32x32x16_bf16 v[16:31], v[88:91], v[168:171], v[16:31]
    v_mfma_f32_32x32x16_bf16 v[32:47], v[92:95], v[168:171], v[32:47]
    v_mfma_f32_32x32x16_bf16 v[48:63], v[88:91], v[172:175], v[48:63]
    v_mfma_f32_32x32x16_bf16 v[64:79], v[92:95], v[172:175], v[64:79]
    s_waitcnt vmcnt(12)
    ds_read_b64_tr_b16 v[80:81], v8 offset:4096
    ds_read_b64_tr_b16 v[82:83], v8 offset:5120
    ds_read_b64_tr_b16 v[84:85], v9 offset:4096
    ds_read_b64_tr_b16 v[86:87], v9 offset:5120
    s_waitcnt lgkmcnt(0)
    v_mfma_f32_32x32x16_bf16 v[16:31], v[80:83], v[176:179], v[16:31]
    v_mfma_f32_32x32x16_bf16 v[32:47], v[84:87], v[176:179], v[32:47]
    v_mfma_f32_32x32x16_bf16 v[48:63], v[80:83], v[180:183], v[48:63]
    v_mfma_f32_32x32x16_bf16 v[64:79], v[84:87], v[180:183], v[64:79]
    s_waitcnt vmcnt(8)
    ds_read_b64_tr_b16 v[88:89], v8 offset:6144
    ds_read_b64_tr_b16 v[90:91], v8 offset:7168
    ds_read_b64_tr_b16 v[92:93], v9 offset:6144
    ds_read_b64_tr_b16 v[94:95], v9 offset:7168
    s_waitcnt lgkmcnt(0)
    v_mfma_f32_32x32x16_bf16 v[16:31], v[88:91], v[184:187], v[16:31]
    v_mfma_f32_32x32x16_bf16 v[32:47], v[92:95], v[184:187], v[32:47]
    v_mfma_f32_32x32x16_bf16 v[48:63], v[88:91], v[188:191], v[48:63]
    v_mfma_f32_32x32x16_bf16 v[64:79], v[92:95], v[188:191], v[64:79]
    s_waitcnt vmcnt(4)
    ds_read_b64_tr_b16 v[80:81], v8 offset:8192
    ds_read_b64_tr_b16 v[82:83], v8 offset:9216
    ds_read_b64_tr_b16 v[84:85], v9 offset:8192
    ds_read_b64_tr_b16 v[86:87], v9 offset:9216
    s_waitcnt lgkmcnt(0)
    v_mfma_f32_32x32x16_bf16 v[16:31], v[80:83], v[192:195], v[16:31]
    v_mfma_f32_32x32x16_bf16 v[32:47], v[84:87], v[192:195], v[32:47]
    v_mfma_f32_32x32x16_bf16 v[48:63], v[80:83], v[196:199], v[48:63]
    v_mfma_f32_32x32x16_bf16 v[64:79], v[84:87], v[196:199], v[64:79]
    s_waitcnt vmcnt(0)
    ds_read_b64_tr_b16 v[88:89], v8 offset:10240
    ds_read_b64_tr_b16 v[90:91], v8 offset:11264
    ds_read_b64_tr_b16 v[92:93], v9 offset:10240
    ds_read_b64_tr_b16 v[94:95], v9 offset:11264
    s_waitcnt lgkmcnt(0)
    v_mfma_f32_32x32x16_bf16 v[16:31], v[88:91], v[200:203], v[16:31]
    v_mfma_f32_32x32x16_bf16 v[32:47], v[92:95], v[200:203], v[32:47]
    v_mfma_f32_32x32x16_bf16 v[48:63], v[88:91], v[204:207], v[48:63]
    v_mfma_f32_32x32x16_bf16 v[64:79], v[92:95], v[204:207], v[64:79]
    s_nop 15
    s_nop 7
    v_lshlrev_b32 v10, 4, v2
    v_add_u32 v10, s26, v10
    ds_write_b128 v10, v[16:19] offset:0
    v_xor_b32 v11, 32, v10
    ds_write_b128 v11, v[20:23] offset:1024
    v_xor_b32 v11, 64, v10
    ds_write_b128 v11, v[24:27] offset:2048
    v_xor_b32 v11, 96, v10
    ds_write_b128 v11, v[28:31] offset:3072
    v_xor_b32 v11, 128, v10
    ds_write_b128 v11, v[32:35] offset:4096
    v_xor_b32 v11, 160, v10
    ds_write_b128 v11, v[36:39] offset:5120
    v_xor_b32 v11, 192, v10
    ds_write_b128 v11, v[40:43] offset:6144
    v_xor_b32 v11, 224, v10
    ds_write_b128 v11, v[44:47] offset:7168
    ds_write_b128 v10, v[48:51] offset:8192
    v_xor_b32 v11, 32, v10
    ds_write_b128 v11, v[52:55] offset:9216
    v_xor_b32 v11, 64, v10
    ds_write_b128 v11, v[56:59] offset:10240
    v_xor_b32 v11, 96, v10
    ds_write_b128 v11, v[60:63] offset:11264
    v_xor_b32 v11, 128, v10
    ds_write_b128 v11, v[64:67] offset:12288
    v_xor_b32 v11, 160, v10
    ds_write_b128 v11, v[68:71] offset:13312
    v_xor_b32 v11, 192, v10
    ds_write_b128 v11, v[72:75] offset:14336
    v_xor_b32 v11, 224, v10
    ds_write_b128 v11, v[76:79] offset:15360
    v_lshrrev_b32 v10, 3, v2
    s_and_b32 s30, s22, 3
    s_lshl_b32 s30, s30, 3
    v_add_u32 v10, s30, v10
    v_lshlrev_b32 v11, 1, v6
    v_xor_b32 v10, v10, v11
    v_lshlrev_b32 v10, 4, v10
    v_lshl_add_u32 v10, v6, 10, v10
    s_lshr_b32 s30, s22, 2
    s_lshl_b32 s30, s30, 13
    v_add_u32 v10, s30, v10
    s_waitcnt lgkmcnt(0)
    s_barrier
    v_add_u32 v11, 0x10000, v10
    ds_read_b128 v[96:99], v10 offset:0
    ds_read_b128 v[100:103], v10 offset:512
    ds_read_b128 v[104:107], v10 offset:16384
    ds_read_b128 v[108:111], v10 offset:16896
    ds_read_b128 v[112:115], v10 offset:32768
    ds_read_b128 v[116:119], v10 offset:33280
    ds_read_b128 v[120:123], v10 offset:49152
    ds_read_b128 v[124:127], v10 offset:49664
    ds_read_b128 v[128:131], v11 offset:0
    ds_read_b128 v[132:135], v11 offset:512
    ds_read_b128 v[136:139], v11 offset:16384
    ds_read_b128 v[140:143], v11 offset:16896
    ds_read_b128 v[144:147], v11 offset:32768
    ds_read_b128 v[148:151], v11 offset:33280
    ds_read_b128 v[152:155], v11 offset:49152
    ds_read_b128 v[156:159], v11 offset:49664
    s_waitcnt vmcnt(0)
    v_lshlrev_b32 v16, 16, v12
    v_and_b32 v17, 0xffff0000, v12
    v_lshlrev_b32 v18, 16, v13
    v_and_b32 v19, 0xffff0000, v13
    v_lshlrev_b32 v20, 16, v14
    v_and_b32 v21, 0xffff0000, v14
    v_lshlrev_b32 v22, 16, v15
    v_and_b32 v23, 0xffff0000, v15
    s_waitcnt lgkmcnt(12)
    v_add_f32 v96, v96, v104
    v_add_f32 v97, v97, v105
    v_add_f32 v98, v98, v106
    v_add_f32 v99, v99, v107
    v_add_f32 v100, v100, v108
    v_add_f32 v101, v101, v109
    v_add_f32 v102, v102, v110
    v_add_f32 v103, v103, v111
    s_waitcnt lgkmcnt(10)
    v_add_f32 v96, v96, v112
    v_add_f32 v97, v97, v113
    v_add_f32 v98, v98, v114
    v_add_f32 v99, v99, v115
    v_add_f32 v100, v100, v116
    v_add_f32 v101, v101, v117
    v_add_f32 v102, v102, v118
    v_add_f32 v103, v103, v119
    s_waitcnt lgkmcnt(8)
    v_add_f32 v96, v96, v120
    v_add_f32 v97, v97, v121
    v_add_f32 v98, v98, v122
    v_add_f32 v99, v99, v123
    v_add_f32 v100, v100, v124
    v_add_f32 v101, v101, v125
    v_add_f32 v102, v102, v126
    v_add_f32 v103, v103, v127
    s_waitcnt lgkmcnt(6)
    v_add_f32 v96, v96, v128
    v_add_f32 v97, v97, v129
    v_add_f32 v98, v98, v130
    v_add_f32 v99, v99, v131
    v_add_f32 v100, v100, v132
    v_add_f32 v101, v101, v133
    v_add_f32 v102, v102, v134
    v_add_f32 v103, v103, v135
    s_waitcnt lgkmcnt(4)
    v_add_f32 v96, v96, v136
    v_add_f32 v97, v97, v137
    v_add_f32 v98, v98, v138
    v_add_f32 v99, v99, v139
    v_add_f32 v100, v100, v140
    v_add_f32 v101, v101, v141
    v_add_f32 v102, v102, v142
    v_add_f32 v103, v103, v143
    s_waitcnt lgkmcnt(2)
    v_add_f32 v96, v96, v144
    v_add_f32 v97, v97, v145
    v_add_f32 v98, v98, v146
    v_add_f32 v99, v99, v147
    v_add_f32 v100, v100, v148
    v_add_f32 v101, v101, v149
    v_add_f32 v102, v102, v150
    v_add_f32 v103, v103, v151
    s_waitcnt lgkmcnt(0)
    v_add_f32 v96, v96, v152
    v_add_f32 v97, v97, v153
    v_add_f32 v98, v98, v154
    v_add_f32 v99, v99, v155
    v_add_f32 v100, v100, v156
    v_add_f32 v101, v101, v157
    v_add_f32 v102, v102, v158
    v_add_f32 v103, v103, v159
    v_add_f32 v16, v16, v96
    v_add_f32 v17, v17, v97
    v_add_f32 v18, v18, v98
    v_add_f32 v19, v19, v99
    v_cvt_pk_bf16_f32 v24, v16, v17
    v_cvt_pk_bf16_f32 v25, v18, v19
    v_add_f32 v20, v20, v100
    v_add_f32 v21, v21, v101
    v_add_f32 v22, v22, v102
    v_add_f32 v23, v23, v103
    v_cvt_pk_bf16_f32 v26, v20, v21
    v_cvt_pk_bf16_f32 v27, v22, v23
    buffer_store_dwordx4 v[24:27], v5, s[16:19], s31 offen
    s_waitcnt vmcnt(0)
K5_END:
    s_endpgm
K_CODE_END:
.section .rodata,"a"
.p2align 6
.amdhsa_kernel k1_qkv_kernel
  .amdhsa_next_free_vgpr 192
  .amdhsa_next_free_sgpr 102
  .amdhsa_accum_offset 192
  .amdhsa_group_segment_fixed_size 0
  .amdhsa_kernarg_size 80
  .amdhsa_user_sgpr_count 2
  .amdhsa_user_sgpr_kernarg_segment_ptr 1
  .amdhsa_system_sgpr_workgroup_id_x 1
.end_amdhsa_kernel
.p2align 6
.amdhsa_kernel k2_attn_kernel
  .amdhsa_next_free_vgpr 248
  .amdhsa_next_free_sgpr 102
  .amdhsa_accum_offset 248
  .amdhsa_group_segment_fixed_size 0
  .amdhsa_kernarg_size 80
  .amdhsa_user_sgpr_count 2
  .amdhsa_user_sgpr_kernarg_segment_ptr 1
  .amdhsa_system_sgpr_workgroup_id_x 1
.end_amdhsa_kernel
.p2align 6
.amdhsa_kernel k3_wo_kernel
  .amdhsa_next_free_vgpr 192
  .amdhsa_next_free_sgpr 102
  .amdhsa_accum_offset 192
  .amdhsa_group_segment_fixed_size 0
  .amdhsa_kernarg_size 80
  .amdhsa_user_sgpr_count 2
  .amdhsa_user_sgpr_kernarg_segment_ptr 1
  .amdhsa_system_sgpr_workgroup_id_x 1
.end_amdhsa_kernel
.p2align 6
.amdhsa_kernel k4_ffn1_kernel
  .amdhsa_next_free_vgpr 256
  .amdhsa_next_free_sgpr 102
  .amdhsa_accum_offset 256
  .amdhsa_group_segment_fixed_size 0
  .amdhsa_kernarg_size 80
  .amdhsa_user_sgpr_count 2
  .amdhsa_user_sgpr_kernarg_segment_ptr 1
  .amdhsa_system_sgpr_workgroup_id_x 1
.end_amdhsa_kernel
.p2align 6
.amdhsa_kernel k5_down_kernel
  .amdhsa_next_free_vgpr 208
  .amdhsa_next_free_sgpr 102
  .amdhsa_accum_offset 208
  .amdhsa_group_segment_fixed_size 0
  .amdhsa_kernarg_size 80
  .amdhsa_user_sgpr_count 2
  .amdhsa_user_sgpr_kernarg_segment_ptr 1
  .amdhsa_system_sgpr_workgroup_id_x 1
.end_amdhsa_kernel
```
